```python
import torch

def _softmax(x, axis=-1):
    return torch.softmax(x, dim=axis)
def _gelu(x):
    return torch.nn.functional.gelu(x, approximate="tanh")
def _silu(x):
    return torch.nn.functional.silu(x)
def _sigmoid(x):
    return torch.sigmoid(x)
def _layernorm(x, axis=-1, eps=1e-5):
    m = x.mean(dim=axis, keepdim=True)
    v = x.var(dim=axis, keepdim=True, unbiased=False)
    return (x - m) / torch.sqrt(v + eps)
def _scatter_add(tgt, idx, src, axis=0):
    return tgt.clone().index_add_(axis, idx, src)
def _segment_sum(src, seg, n):
    out = torch.zeros((n,) + src.shape[1:], dtype=src.dtype)
    return out.index_add_(0, seg, src)
def _pad(x, pw):
    flat = tuple(v for pair in reversed(pw) for v in pair)
    return torch.nn.functional.pad(x, flat)

kernel_name = 'interleave_layers__sliding_local_dilated__ssm_conv_h3__prompt'

def setup_inputs():

    _w = (lambda a: (lambda t: t.to(torch.bfloat16) if t.is_floating_point() else t)(torch.as_tensor(a)))
    def _A_setup():
        B, S, D = 1, 2048, 512
        return {
            "x": _w((lambda *s: torch.randn(*s, dtype=torch.bfloat16) * 0.05)(B, S, D)),
            "wqkv": _w((lambda *s: torch.randn(*s, dtype=torch.bfloat16) * 0.05)(D, 3 * D)),
            "wo": _w((lambda *s: torch.randn(*s, dtype=torch.bfloat16) * 0.05)(D, D)),
        }
    _A_in = _A_setup()

    def _B_setup():
        B, S, D = 1, 2048, 512
        ks = 4
        return {
            "q": _w((lambda *s: torch.randn(*s, dtype=torch.bfloat16) * 0.05)(B, S, D)),
            "k": _w((lambda *s: torch.randn(*s, dtype=torch.bfloat16) * 0.4)(B, S, D)),
            "v": _w((lambda *s: torch.randn(*s, dtype=torch.bfloat16) * 0.4)(B, S, D)),
            "shift_k": _w((lambda *s: torch.randn(*s, dtype=torch.bfloat16) * 0.4)(D, ks) * 0.5),
            "ssm_k": _w((lambda *s: torch.randn(*s, dtype=torch.bfloat16) * 0.8)(D, S) * (1.0 / S ** 0.5)),
            "ssm_D": _w((lambda *s: torch.randn(*s, dtype=torch.bfloat16) * 0.4)(D)),
        }
    _B_in = _B_setup()

    return {
        "A_x": _A_in["x"],
        "A_wqkv": _A_in["wqkv"],
        "A_wo": _A_in["wo"],
        "B_q": _B_in["q"],
        "B_k": _B_in["k"],
        "B_v": _B_in["v"],
        "B_shift_k": _B_in["shift_k"],
        "B_ssm_k": _B_in["ssm_k"],
        "B_ssm_D": _B_in["ssm_D"],
    }

def reference(A_x, A_wqkv, A_wo, B_q, B_k, B_v, B_shift_k, B_ssm_k, B_ssm_D):
    def _A_ref(x, wqkv, wo):
        B, S, D = x.shape
        H = 32; Dh = D // H
        W, dil = 8, 2
        qkv = (lambda x, *d: x.permute(*d))((x @ wqkv).reshape(B, S, 3, H, Dh), 2, 0, 3, 1, 4)
        q, k, v = qkv[0], qkv[1], qkv[2]
        scale = Dh ** -0.5
        pos = torch.arange(S)
        off = torch.arange(W) * dil
        idx = pos[:, None] - off[None, :]
        mask = idx >= 0
        idx_c = torch.where(mask, idx, 0).reshape(-1)
        kg = k[:, :, idx_c, :].reshape(B, H, S, W, Dh)
        vg = v[:, :, idx_c, :].reshape(B, H, S, W, Dh)
        logits = torch.einsum("bhsd,bhswd->bhsw", q, kg) * scale
        logits = torch.where(mask[None, None, :, :], logits, -1e9)
        attn = _softmax(logits, axis=-1)
        o = torch.einsum("bhsw,bhswd->bhsd", attn, vg)
        return (lambda x, *d: x.permute(*d))(o, 0, 2, 1, 3).reshape(B, S, D) @ wo

    def _B_ref(q, k, v, shift_k, ssm_k, ssm_D):
        B, S, D = q.shape
        ks = shift_k.shape[-1]
        k_pad = _pad(k, ((0, 0), (ks - 1, 0), (0, 0)))
        k_shift = torch.zeros_like(k)
        for t in range(ks):
            k_shift = k_shift + k_pad[:, t:t + S, :] * shift_k[:, ks - 1 - t][None, None, :]
        kv = k_shift * v
        L = 2 * S
        kv_pad = _pad(kv, ((0, 0), (0, S), (0, 0)))
        kf_pad = _pad(ssm_k, ((0, 0), (0, S)))
        kv_f = (lambda x, axes=(-2,-1): torch.fft.rfft2(x.float(), dim=axes))(kv_pad[:, None, :, :], axes=(1, 2))
        kf_f = (lambda x, axes=(-2,-1): torch.fft.rfft2(x.float(), dim=axes))(kf_pad[:, None, :], axes=(1, 2))
        kf_f = (lambda x, *d: x.permute(*d))(kf_f, 1, 2, 0)
        y_f = kv_f * kf_f[None, :, :, :]
        y = (lambda x, s, axes=(-2,-1): torch.fft.irfft2(x, s=s, dim=axes).to(torch.bfloat16))(y_f, (1, L), axes=(1, 2))[:, 0, :S, :]
        y = y + kv * ssm_D[None, None, :]
        return q * y

    x = A_x
    x = x + _A_ref(_layernorm(x, axis=-1), A_wqkv, A_wo)
    x = x + _B_ref(_layernorm(x, axis=-1), B_k, B_v, B_shift_k, B_ssm_k, B_ssm_D)
    x = x + _A_ref(_layernorm(x, axis=-1), A_wqkv, A_wo)
    x = x + _B_ref(_layernorm(x, axis=-1), B_k, B_v, B_shift_k, B_ssm_k, B_ssm_D)
    return x
```

```asm
; @launch grid=(256,1,1) block=(256,1,1) lds=163840
    .amdgcn_target "amdgcn-amd-amdhsa--gfx950"
    .text
    .globl interleave_layers__sliding_local_dilated__ssm_conv_h3__prompt_kernel
    .p2align 8
    .type interleave_layers__sliding_local_dilated__ssm_conv_h3__prompt_kernel,@function
interleave_layers__sliding_local_dilated__ssm_conv_h3__prompt_kernel:
    s_cmp_ge_u32 s2, 256
    s_cbranch_scc1 L_end_1
    s_load_dwordx4 s[88:91], s[0:1], 0
    s_load_dwordx2 s[92:93], s[0:1], 16
    s_load_dwordx4 s[96:99], s[0:1], 32
    s_load_dwordx2 s[94:95], s[0:1], 88
    v_and_b32 v1, 63, v0
    v_lshrrev_b32 v62, 6, v0
    v_and_b32 v2, 15, v1
    v_readfirstlane_b32 s44, v62
    v_lshrrev_b32 v3, 4, v1
    v_lshlrev_b32 v4, 4, v1
    v_mov_b32 v9, 0
    s_and_b32 s45, s2, 7
    s_lshl_b32 s45, s45, 2
    s_lshr_b32 s49, s2, 6
    s_add_u32 s45, s45, s49
    s_lshr_b32 s46, s2, 3
    s_and_b32 s46, s46, 7
    s_lshr_b32 s47, s45, 4
    s_and_b32 s48, s45, 15
    s_and_b32 s74, s2, 0x78
    s_cmp_lg_u32 s74, 0
    s_cbranch_scc1 L_nopf_2
    s_getpc_b64 s[76:77]
    s_and_b32 s76, s76, 0xffffff00
    v_lshlrev_b32 v62, 7, v0
    v_min_u32 v62, CODE_LIMIT, v62
    global_load_dword v253, v62, s[76:77]
L_nopf_2:
    s_lshl_b32 s74, s44, 2
    v_add_u32 v62, s74, v3
    v_xor_b32 v62, v62, v2
    v_lshlrev_b32 v62, 4, v62
    v_lshl_add_u32 v5, v3, 11, v62
    v_lshrrev_b32 v62, 3, v1
    s_lshl_b32 s74, s44, 3
    v_add_u32 v62, s74, v62
    v_bfe_u32 v63, v62, 3, 1
    v_lshlrev_b32 v63, 1, v63
    v_bfe_u32 v64, v62, 1, 1
    v_or_b32 v63, v63, v64
    v_bfe_u32 v64, v1, 1, 2
    v_xor_b32 v63, v63, v64
    v_lshlrev_b32 v63, 5, v63
    v_and_b32 v64, 1, v1
    v_lshl_add_u32 v63, v64, 4, v63
    v_mul_u32_u24 v6, 3072, v62
    v_add_u32 v6, v6, v63
    s_lshl_b32 s56, s48, 17
    s_lshl_b32 s74, s47, 10
    s_add_u32 s56, s56, s74
    s_mul_i32 s55, s44, 3072
    s_add_u32 s55, s55, 81920
    s_lshl_b32 s75, s44, 13
    s_add_u32 s75, s75, s56
    s_sub_u32 s75, s75, 32768
    s_lshl_b32 s76, s44, 10
    s_lshl_b32 s77, s46, 7
    s_add_u32 s74, s49, 0
    s_and_b32 s74, s74, 3
    s_lshl_b32 s62, s74, 8
    s_add_u32 s62, s62, s75
    s_mul_i32 s66, s74, 20480
    s_add_u32 s66, s66, s76
    s_mul_i32 s70, s74, 393216
    s_add_u32 s70, s70, s77
    s_add_u32 s74, s49, 1
    s_and_b32 s74, s74, 3
    s_lshl_b32 s63, s74, 8
    s_add_u32 s63, s63, s75
    s_mul_i32 s67, s74, 20480
    s_add_u32 s67, s67, s76
    s_mul_i32 s71, s74, 393216
    s_add_u32 s71, s71, s77
    s_add_u32 s74, s49, 2
    s_and_b32 s74, s74, 3
    s_lshl_b32 s64, s74, 8
    s_add_u32 s64, s64, s75
    s_mul_i32 s68, s74, 20480
    s_add_u32 s68, s68, s76
    s_mul_i32 s72, s74, 393216
    s_add_u32 s72, s72, s77
    s_add_u32 s74, s49, 3
    s_and_b32 s74, s74, 3
    s_lshl_b32 s65, s74, 8
    s_add_u32 s65, s65, s75
    s_mul_i32 s69, s74, 20480
    s_add_u32 s69, s69, s76
    s_mul_i32 s73, s74, 393216
    s_add_u32 s73, s73, s77
    s_add_u32 s74, s2, 0
    s_and_b32 s74, s74, 3
    s_mul_i32 s82, s74, 98304
    s_add_u32 s74, s2, 1
    s_and_b32 s74, s74, 3
    s_mul_i32 s83, s74, 98304
    s_add_u32 s74, s2, 2
    s_and_b32 s74, s74, 3
    s_mul_i32 s84, s74, 98304
    s_add_u32 s74, s2, 3
    s_and_b32 s74, s74, 3
    s_mul_i32 s85, s74, 98304
    s_cmp_eq_u32 s44, 0
    s_cselect_b32 s86, 0xffff0000, -1
    s_mov_b32 s87, -1
    s_waitcnt lgkmcnt(0)
    s_mov_b32 s4, s88
    s_mov_b32 s5, s89
    s_mov_b32 s6, 2097152
    s_mov_b32 s7, 0x00020000
    s_mov_b32 s8, s90
    s_mov_b32 s9, s91
    s_mov_b32 s10, 1572864
    s_mov_b32 s11, 0x00020000
    s_add_u32 m0, s66, 0
    s_cmp_lt_u32 s44, 2
    s_cselect_b32 s74, 2146435072, s62
    s_mov_b64 exec, s[86:87]
    buffer_load_dwordx4 v5, s[4:7], s74 offen lds
    s_mov_b64 exec, -1
    s_add_u32 m0, s66, 4096
    s_add_u32 s74, s62, 32768
    buffer_load_dwordx4 v5, s[4:7], s74 offen lds
    s_add_u32 m0, s66, 8192
    s_add_u32 s74, s62, 65536
    buffer_load_dwordx4 v5, s[4:7], s74 offen lds
    s_add_u32 m0, s66, 12288
    s_add_u32 s74, s62, 98304
    buffer_load_dwordx4 v5, s[4:7], s74 offen lds
    s_add_u32 m0, s66, 16384
    s_add_u32 s74, s62, 131072
    buffer_load_dwordx4 v5, s[4:7], s74 offen lds
    s_add_u32 m0, s55, 0
    s_add_u32 s74, s70, s82
    buffer_load_dwordx4 v6, s[8:11], s74 offen offset:0 lds
    buffer_load_dwordx4 v6, s[8:11], s74 offen offset:1024 lds
    buffer_load_dwordx4 v6, s[8:11], s74 offen offset:2048 lds
    s_mov_b32 s12, s94
    s_mov_b32 s13, s95
    s_mov_b32 s14, 11534336
    s_mov_b32 s15, 0x00020000
    s_mov_b32 s16, s96
    s_mov_b32 s17, s97
    s_mov_b32 s18, 2097152
    s_mov_b32 s19, 0x00020000
    s_mov_b32 s20, s98
    s_mov_b32 s21, s99
    s_mov_b32 s22, 2097152
    s_mov_b32 s23, 0x00020000
    s_mov_b32 s28, s92
    s_mov_b32 s29, s93
    s_mov_b32 s30, 524288
    s_mov_b32 s31, 0x00020000
    s_load_dwordx4 s[88:91], s[0:1], 48
    s_load_dwordx4 s[92:95], s[0:1], 64
    s_load_dwordx2 s[96:97], s[0:1], 80
    s_lshr_b32 s74, s2, 3
    s_lshl_b32 s74, s74, 16
    s_and_b32 s75, s2, 7
    s_lshl_b32 s76, s75, 7
    s_add_u32 s74, s74, s76
    v_and_b32 v64, 7, v0
    v_lshrrev_b32 v65, 3, v0
    v_lshlrev_b32 v66, 11, v65
    v_lshl_add_u32 v66, v64, 4, v66
    v_add_u32 v66, s74, v66
    v_add_u32 v67, 0xfffff400, v66
    v_add_u32 v68, 0xfffff800, v66
    v_add_u32 v69, 0xfffffc00, v66
    buffer_load_dwordx4 v[184:187], v67, s[16:19], 0 offen
    buffer_load_dwordx4 v[188:191], v68, s[16:19], 0 offen
    buffer_load_dwordx4 v[192:195], v69, s[16:19], 0 offen
    buffer_load_dwordx4 v[196:199], v66, s[16:19], 0 offen
    buffer_load_dwordx4 v[200:203], v66, s[16:19], 0 offen offset:1024
    buffer_load_dwordx4 v[204:207], v66, s[20:23], 0 offen
    buffer_load_dwordx4 v[208:211], v66, s[20:23], 0 offen offset:1024
    s_waitcnt lgkmcnt(0)
    s_mov_b32 s24, s88
    s_mov_b32 s25, s89
    s_mov_b32 s26, 4096
    s_mov_b32 s27, 0x00020000
    s_mov_b32 s32, s90
    s_mov_b32 s33, s91
    s_mov_b32 s34, 2097152
    s_mov_b32 s35, 0x00020000
    s_mov_b32 s36, s94
    s_mov_b32 s37, s95
    s_mov_b32 s38, 2097152
    s_mov_b32 s39, 0x00020000
    s_mov_b32 s40, s96
    s_mov_b32 s41, s97
    s_mov_b32 s42, 256
    s_mov_b32 s43, 0x00020000
    s_lshl_b32 s77, s2, 2
    s_load_dword s54, s[92:93], s77
    s_getreg_b32 s53, hwreg(HW_REG_XCC_ID)
    s_and_b32 s53, s53, 15
    s_lshl_b32 s76, s75, 9
    v_lshlrev_b32 v67, 6, v64
    buffer_load_dwordx4 v[212:215], v67, s[24:27], s76 offen offset:0
    buffer_load_dwordx4 v[216:219], v67, s[24:27], s76 offen offset:16
    buffer_load_dwordx4 v[220:223], v67, s[24:27], s76 offen offset:32
    buffer_load_dwordx4 v[224:227], v67, s[24:27], s76 offen offset:48
    s_or_b32 s74, s2, s44
    s_cmp_lg_u32 s74, 0
    s_cbranch_scc1 L_noep_3
    s_memrealtime s[78:79]
    s_waitcnt lgkmcnt(0)
    s_or_b32 s78, s78, 1
    v_mov_b32 v70, s78
    v_mov_b32 v71, s79
    s_mov_b64 exec, 1
    buffer_store_dwordx2 v[70:71], v9, s[40:43], 0 offen sc1
    s_mov_b64 exec, -1
L_noep_3:
    s_add_u32 m0, s55, 12288
    s_add_u32 s74, s70, s83
    buffer_load_dwordx4 v6, s[8:11], s74 offen offset:0 lds
    buffer_load_dwordx4 v6, s[8:11], s74 offen offset:1024 lds
    buffer_load_dwordx4 v6, s[8:11], s74 offen offset:2048 lds
    v_bfe_u32 v70, v1, 2, 2
    v_and_b32 v71, 1, v3
    v_lshlrev_b32 v71, 1, v71
    v_lshrrev_b32 v72, 1, v70
    v_or_b32 v71, v71, v72
    v_xor_b32 v72, s44, v71
    v_lshlrev_b32 v72, 5, v72
    v_lshl_add_u32 v72, v70, 7, v72
    v_and_b32 v73, 3, v1
    v_lshl_add_u32 v72, v73, 3, v72
    v_mul_u32_u24 v74, 3072, v3
    v_add_u32 v72, v72, v74
    v_add_u32 v7, 81920, v72
    v_lshl_add_u32 v72, v3, 3, v70
    v_lshlrev_b32 v72, 7, v72
    v_lshl_add_u32 v72, v73, 3, v72
    v_add_u32 v72, 81920, v72
    v_xor_b32 v74, 0, v71
    v_lshl_add_u32 v58, v74, 5, v72
    v_xor_b32 v74, 1, v71
    v_lshl_add_u32 v59, v74, 5, v72
    v_xor_b32 v74, 2, v71
    v_lshl_add_u32 v60, v74, 5, v72
    v_xor_b32 v74, 3, v71
    v_lshl_add_u32 v61, v74, 5, v72
    s_lshl_b32 s76, s44, 10
    s_add_u32 s77, s2, 0
    s_and_b32 s77, s77, 3
    s_lshl_b32 s77, s77, 2
    v_add_u32 v70, s77, v3
    v_xor_b32 v70, v70, v2
    v_lshlrev_b32 v70, 4, v70
    v_lshl_add_u32 v70, v2, 8, v70
    v_subrev_u32 v70, s76, v70
    v_add_u32 v10, s66, v70
    v_add_u32 v14, s67, v70
    v_add_u32 v18, s68, v70
    v_add_u32 v22, s69, v70
    s_add_u32 s77, s2, 1
    s_and_b32 s77, s77, 3
    s_lshl_b32 s77, s77, 2
    v_add_u32 v70, s77, v3
    v_xor_b32 v70, v70, v2
    v_lshlrev_b32 v70, 4, v70
    v_lshl_add_u32 v70, v2, 8, v70
    v_subrev_u32 v70, s76, v70
    v_add_u32 v11, s66, v70
    v_add_u32 v15, s67, v70
    v_add_u32 v19, s68, v70
    v_add_u32 v23, s69, v70
    s_add_u32 s77, s2, 2
    s_and_b32 s77, s77, 3
    s_lshl_b32 s77, s77, 2
    v_add_u32 v70, s77, v3
    v_xor_b32 v70, v70, v2
    v_lshlrev_b32 v70, 4, v70
    v_lshl_add_u32 v70, v2, 8, v70
    v_subrev_u32 v70, s76, v70
    v_add_u32 v12, s66, v70
    v_add_u32 v16, s67, v70
    v_add_u32 v20, s68, v70
    v_add_u32 v24, s69, v70
    s_add_u32 s77, s2, 3
    s_and_b32 s77, s77, 3
    s_lshl_b32 s77, s77, 2
    v_add_u32 v70, s77, v3
    v_xor_b32 v70, v70, v2
    v_lshlrev_b32 v70, 4, v70
    v_lshl_add_u32 v70, v2, 8, v70
    v_subrev_u32 v70, s76, v70
    v_add_u32 v13, s66, v70
    v_add_u32 v17, s67, v70
    v_add_u32 v21, s68, v70
    v_add_u32 v25, s69, v70
    v_lshlrev_b32 v8, 11, v2
    v_lshl_add_u32 v8, v3, 3, v8
    v_lshlrev_b32 v35, 3, v1
    v_lshlrev_b32 v70, 2, v3
    v_mov_b32 v72, 4048155338
    s_cmp_eq_u32 s48, 0
    s_cselect_b32 s76, -1, 0
    s_mov_b32 s77, s76
    v_add_u32 v71, 0, v70
    v_sub_u32 v71, v2, v71
    v_cmp_gt_u32 vcc, 8, v71
    v_add_u32 v71, 16, v71
    v_cmp_gt_u32 s[78:79], 8, v71
    v_cndmask_b32 v38, v72, 0, vcc
    v_cndmask_b32 v74, 0, -1, vcc
    v_cndmask_b32 v42, v72, 0, s[78:79]
    v_cndmask_b32 v78, 0, -1, s[78:79]
    v_cndmask_b32 v46, v42, v72, s[76:77]
    v_add_u32 v71, 1, v70
    v_sub_u32 v71, v2, v71
    v_cmp_gt_u32 vcc, 8, v71
    v_add_u32 v71, 16, v71
    v_cmp_gt_u32 s[78:79], 8, v71
    v_cndmask_b32 v39, v72, 0, vcc
    v_cndmask_b32 v75, 0, -1, vcc
    v_cndmask_b32 v43, v72, 0, s[78:79]
    v_cndmask_b32 v79, 0, -1, s[78:79]
    v_cndmask_b32 v47, v43, v72, s[76:77]
    v_add_u32 v71, 2, v70
    v_sub_u32 v71, v2, v71
    v_cmp_gt_u32 vcc, 8, v71
    v_add_u32 v71, 16, v71
    v_cmp_gt_u32 s[78:79], 8, v71
    v_cndmask_b32 v40, v72, 0, vcc
    v_cndmask_b32 v76, 0, -1, vcc
    v_cndmask_b32 v44, v72, 0, s[78:79]
    v_cndmask_b32 v80, 0, -1, s[78:79]
    v_cndmask_b32 v48, v44, v72, s[76:77]
    v_add_u32 v71, 3, v70
    v_sub_u32 v71, v2, v71
    v_cmp_gt_u32 vcc, 8, v71
    v_add_u32 v71, 16, v71
    v_cmp_gt_u32 s[78:79], 8, v71
    v_cndmask_b32 v41, v72, 0, vcc
    v_cndmask_b32 v77, 0, -1, vcc
    v_cndmask_b32 v45, v72, 0, s[78:79]
    v_cndmask_b32 v81, 0, -1, s[78:79]
    v_cndmask_b32 v49, v45, v72, s[76:77]
    s_mov_b32 s78, 0xffff
    v_bfi_b32 v50, s78, v74, v75
    v_bfi_b32 v52, s78, v78, v79
    v_bfi_b32 v51, s78, v76, v77
    v_bfi_b32 v53, s78, v80, v81
    v_mov_b32 v54, 0x3f803f80
    v_mov_b32 v55, 0x3f803f80
    v_mov_b32 v56, 0x3f803f80
    v_mov_b32 v57, 0x3f803f80
    v_mul_u32_u24 v70, 20480, v3
    v_lshl_add_u32 v70, v2, 4, v70
    ds_write_b128 v70, v[54:57] offset:0
    s_add_u32 s19, s44, 1
    s_lshl_b32 s19, s19, 12
    s_lshl_b32 s18, s45, 8
    s_lshl_b32 s76, s46, 5
    s_add_u32 s18, s18, s76
    s_lshl_b32 s76, s44, 3
    s_add_u32 s18, s18, s76
    s_lshr_b32 s60, s44, 1
    s_and_b32 s59, s44, 1
    s_lshl_b32 s57, s2, 1
    s_add_u32 s57, s57, s60
    s_lshl_b32 s57, s57, 12
    s_mul_i32 s58, s60, 21248
    s_add_u32 m0, s55, 24576
    s_add_u32 s74, s70, s84
    buffer_load_dwordx4 v6, s[8:11], s74 offen offset:0 lds
    buffer_load_dwordx4 v6, s[8:11], s74 offen offset:1024 lds
    buffer_load_dwordx4 v6, s[8:11], s74 offen offset:2048 lds
    s_waitcnt vmcnt(6)
    v_lshlrev_b32 v228, 16, v184
    v_and_b32 v229, 0xffff0000, v184
    v_lshlrev_b32 v230, 16, v188
    v_and_b32 v231, 0xffff0000, v188
    v_lshlrev_b32 v232, 16, v192
    v_and_b32 v233, 0xffff0000, v192
    v_lshlrev_b32 v234, 16, v196
    v_and_b32 v235, 0xffff0000, v196
    v_lshlrev_b32 v236, 16, v200
    v_and_b32 v237, 0xffff0000, v200
    v_lshlrev_b32 v238, 16, v212
    v_lshlrev_b32 v239, 16, v214
    v_and_b32 v240, 0xffff0000, v212
    v_and_b32 v241, 0xffff0000, v214
    v_lshlrev_b32 v242, 16, v213
    v_lshlrev_b32 v243, 16, v215
    v_and_b32 v244, 0xffff0000, v213
    s_add_u32 m0, s67, 0
    s_cmp_lt_u32 s44, 2
    s_cselect_b32 s74, 2146435072, s63
    s_mov_b64 exec, s[86:87]
    buffer_load_dwordx4 v5, s[4:7], s74 offen lds
    s_mov_b64 exec, -1
    v_and_b32 v245, 0xffff0000, v215
    v_lshlrev_b32 v246, 16, v204
    v_and_b32 v247, 0xffff0000, v204
    v_lshlrev_b32 v248, 16, v208
    v_and_b32 v249, 0xffff0000, v208
    v_pk_mul_f32 v[250:251], v[228:229], v[244:245]
    v_pk_fma_f32 v[250:251], v[230:231], v[242:243], v[250:251]
    v_pk_fma_f32 v[250:251], v[232:233], v[240:241], v[250:251]
    v_pk_fma_f32 v[250:251], v[234:235], v[238:239], v[250:251]
    v_pk_mul_f32 v[250:251], v[250:251], v[246:247]
    v_pk_mul_f32 v[252:253], v[230:231], v[244:245]
    v_pk_fma_f32 v[252:253], v[232:233], v[242:243], v[252:253]
    v_pk_fma_f32 v[252:253], v[234:235], v[240:241], v[252:253]
    v_pk_fma_f32 v[252:253], v[236:237], v[238:239], v[252:253]
    v_pk_mul_f32 v[252:253], v[252:253], v[248:249]
    v_cvt_pk_bf16_f32 v112, v252, v250
    v_cvt_pk_bf16_f32 v113, v253, v251
    s_add_u32 m0, s67, 4096
    s_add_u32 s74, s63, 32768
    buffer_load_dwordx4 v5, s[4:7], s74 offen lds
    v_lshlrev_b32 v228, 16, v185
    v_and_b32 v229, 0xffff0000, v185
    v_lshlrev_b32 v230, 16, v189
    v_and_b32 v231, 0xffff0000, v189
    v_lshlrev_b32 v232, 16, v193
    v_and_b32 v233, 0xffff0000, v193
    v_lshlrev_b32 v234, 16, v197
    v_and_b32 v235, 0xffff0000, v197
    v_lshlrev_b32 v236, 16, v201
    v_and_b32 v237, 0xffff0000, v201
    v_lshlrev_b32 v238, 16, v216
    v_lshlrev_b32 v239, 16, v218
    v_and_b32 v240, 0xffff0000, v216
    v_and_b32 v241, 0xffff0000, v218
    v_lshlrev_b32 v242, 16, v217
    v_lshlrev_b32 v243, 16, v219
    v_and_b32 v244, 0xffff0000, v217
    s_add_u32 m0, s67, 8192
    s_add_u32 s74, s63, 65536
    buffer_load_dwordx4 v5, s[4:7], s74 offen lds
    v_and_b32 v245, 0xffff0000, v219
    v_lshlrev_b32 v246, 16, v205
    v_and_b32 v247, 0xffff0000, v205
    v_lshlrev_b32 v248, 16, v209
    v_and_b32 v249, 0xffff0000, v209
    v_pk_mul_f32 v[250:251], v[228:229], v[244:245]
    v_pk_fma_f32 v[250:251], v[230:231], v[242:243], v[250:251]
    v_pk_fma_f32 v[250:251], v[232:233], v[240:241], v[250:251]
    v_pk_fma_f32 v[250:251], v[234:235], v[238:239], v[250:251]
    v_pk_mul_f32 v[250:251], v[250:251], v[246:247]
    v_pk_mul_f32 v[252:253], v[230:231], v[244:245]
    v_pk_fma_f32 v[252:253], v[232:233], v[242:243], v[252:253]
    v_pk_fma_f32 v[252:253], v[234:235], v[240:241], v[252:253]
    v_pk_fma_f32 v[252:253], v[236:237], v[238:239], v[252:253]
    v_pk_mul_f32 v[252:253], v[252:253], v[248:249]
    v_cvt_pk_bf16_f32 v114, v252, v250
    v_cvt_pk_bf16_f32 v115, v253, v251
    s_add_u32 m0, s67, 12288
    s_add_u32 s74, s63, 98304
    buffer_load_dwordx4 v5, s[4:7], s74 offen lds
    v_lshlrev_b32 v228, 16, v186
    v_and_b32 v229, 0xffff0000, v186
    v_lshlrev_b32 v230, 16, v190
    v_and_b32 v231, 0xffff0000, v190
    v_lshlrev_b32 v232, 16, v194
    v_and_b32 v233, 0xffff0000, v194
    v_lshlrev_b32 v234, 16, v198
    v_and_b32 v235, 0xffff0000, v198
    v_lshlrev_b32 v236, 16, v202
    v_and_b32 v237, 0xffff0000, v202
    v_lshlrev_b32 v238, 16, v220
    v_lshlrev_b32 v239, 16, v222
    v_and_b32 v240, 0xffff0000, v220
    v_and_b32 v241, 0xffff0000, v222
    v_lshlrev_b32 v242, 16, v221
    v_lshlrev_b32 v243, 16, v223
    v_and_b32 v244, 0xffff0000, v221
    s_add_u32 m0, s67, 16384
    s_add_u32 s74, s63, 131072
    buffer_load_dwordx4 v5, s[4:7], s74 offen lds
    v_and_b32 v245, 0xffff0000, v223
    v_lshlrev_b32 v246, 16, v206
    v_and_b32 v247, 0xffff0000, v206
    v_lshlrev_b32 v248, 16, v210
    v_and_b32 v249, 0xffff0000, v210
    v_pk_mul_f32 v[250:251], v[228:229], v[244:245]
    v_pk_fma_f32 v[250:251], v[230:231], v[242:243], v[250:251]
    v_pk_fma_f32 v[250:251], v[232:233], v[240:241], v[250:251]
    v_pk_fma_f32 v[250:251], v[234:235], v[238:239], v[250:251]
    v_pk_mul_f32 v[250:251], v[250:251], v[246:247]
    v_pk_mul_f32 v[252:253], v[230:231], v[244:245]
    v_pk_fma_f32 v[252:253], v[232:233], v[242:243], v[252:253]
    v_pk_fma_f32 v[252:253], v[234:235], v[240:241], v[252:253]
    v_pk_fma_f32 v[252:253], v[236:237], v[238:239], v[252:253]
    v_pk_mul_f32 v[252:253], v[252:253], v[248:249]
    v_cvt_pk_bf16_f32 v116, v252, v250
    v_cvt_pk_bf16_f32 v117, v253, v251
    s_add_u32 m0, s55, 36864
    s_add_u32 s74, s70, s85
    buffer_load_dwordx4 v6, s[8:11], s74 offen offset:0 lds
    buffer_load_dwordx4 v6, s[8:11], s74 offen offset:1024 lds
    buffer_load_dwordx4 v6, s[8:11], s74 offen offset:2048 lds
    v_lshlrev_b32 v228, 16, v187
    v_and_b32 v229, 0xffff0000, v187
    v_lshlrev_b32 v230, 16, v191
    v_and_b32 v231, 0xffff0000, v191
    v_lshlrev_b32 v232, 16, v195
    v_and_b32 v233, 0xffff0000, v195
    v_lshlrev_b32 v234, 16, v199
    v_and_b32 v235, 0xffff0000, v199
    v_lshlrev_b32 v236, 16, v203
    v_and_b32 v237, 0xffff0000, v203
    v_lshlrev_b32 v238, 16, v224
    v_lshlrev_b32 v239, 16, v226
    v_and_b32 v240, 0xffff0000, v224
    v_and_b32 v241, 0xffff0000, v226
    v_lshlrev_b32 v242, 16, v225
    v_lshlrev_b32 v243, 16, v227
    v_and_b32 v244, 0xffff0000, v225
    s_add_u32 m0, s55, 49152
    s_add_u32 s74, s71, s82
    buffer_load_dwordx4 v6, s[8:11], s74 offen offset:0 lds
    buffer_load_dwordx4 v6, s[8:11], s74 offen offset:1024 lds
    buffer_load_dwordx4 v6, s[8:11], s74 offen offset:2048 lds
    v_and_b32 v245, 0xffff0000, v227
    v_lshlrev_b32 v246, 16, v207
    v_and_b32 v247, 0xffff0000, v207
    v_lshlrev_b32 v248, 16, v211
    v_and_b32 v249, 0xffff0000, v211
    v_pk_mul_f32 v[250:251], v[228:229], v[244:245]
    v_pk_fma_f32 v[250:251], v[230:231], v[242:243], v[250:251]
    v_pk_fma_f32 v[250:251], v[232:233], v[240:241], v[250:251]
    v_pk_fma_f32 v[250:251], v[234:235], v[238:239], v[250:251]
    v_pk_mul_f32 v[250:251], v[250:251], v[246:247]
    v_pk_mul_f32 v[252:253], v[230:231], v[244:245]
    v_pk_fma_f32 v[252:253], v[232:233], v[242:243], v[252:253]
    v_pk_fma_f32 v[252:253], v[234:235], v[240:241], v[252:253]
    v_pk_fma_f32 v[252:253], v[236:237], v[238:239], v[252:253]
    v_pk_mul_f32 v[252:253], v[252:253], v[248:249]
    v_cvt_pk_bf16_f32 v118, v252, v250
    v_cvt_pk_bf16_f32 v119, v253, v251
    v_sub_u32 v67, 31, v65
    v_lshrrev_b32 v68, 2, v67
    v_xor_b32 v68, v68, v64
    v_lshlrev_b32 v68, 4, v68
    v_and_b32 v67, 3, v67
    v_lshl_add_u32 v68, v67, 2, v68
    v_lshl_add_u32 v68, v64, 10, v68
    v_add_u32 v68, 147456, v68
    ds_write_b32 v68, v112 offset:0
    ds_write_b32 v68, v113 offset:128
    ds_write_b32 v68, v114 offset:256
    ds_write_b32 v68, v115 offset:384
    ds_write_b32 v68, v116 offset:512
    ds_write_b32 v68, v117 offset:640
    ds_write_b32 v68, v118 offset:768
    ds_write_b32 v68, v119 offset:896
    v_lshrrev_b32 v67, 3, v0
    v_lshrrev_b32 v68, 3, v67
    v_xor_b32 v68, v68, v64
    v_lshlrev_b32 v68, 4, v68
    v_lshl_add_u32 v68, v67, 7, v68
    v_add_u32 v68, 147456, v68
    v_xor_b32 v69, 64, v68
    s_and_b32 s74, s2, 7
    s_lshl_b32 s74, s74, 18
    s_lshr_b32 s75, s2, 3
    s_lshl_b32 s75, s75, 7
    s_sub_u32 s74, s74, s75
    s_add_u32 s74, s74, 6295424
    s_add_u32 s75, s74, 131072
    v_lshlrev_b32 v67, 12, v67
    v_lshl_add_u32 v67, v64, 4, v67
    s_nop 0
    s_waitcnt lgkmcnt(0)
    s_barrier
    ds_read_b128 v[112:115], v68
    ds_read_b128 v[116:119], v69 offset:4096
    v_add_u32 v172, s19, v10
    ds_read_b64_tr_b16 a[0:1], v7 offset:0
    ds_read_b64_tr_b16 a[2:3], v7 offset:512
    ds_read_b64_tr_b16 a[4:5], v7 offset:1024
    ds_read_b64_tr_b16 a[6:7], v7 offset:1536
    ds_read_b64_tr_b16 a[8:9], v7 offset:2048
    ds_read_b64_tr_b16 a[10:11], v7 offset:2560
    ds_read_b128 v[184:187], v10 offset:0
    ds_read_b128 v[188:191], v10 offset:4096
    ds_read_b128 v[192:195], v10 offset:8192
    ds_read_b128 v[196:199], v10 offset:12288
    ds_read_b128 v[200:203], v10 offset:16384
    ds_read_b128 v[204:207], v172
    v_mov_b32 v168, 0
    v_mov_b32 v169, 0
    s_waitcnt lgkmcnt(12)
    buffer_store_dwordx4 v[112:115], v67, s[12:15], s74 offen sc1
    buffer_store_dwordx4 v[116:119], v67, s[12:15], s75 offen sc1
    s_waitcnt vmcnt(13) lgkmcnt(0)
    s_barrier
    v_dot2_f32_bf16 v168, v204, v54, v168
    v_dot2_f32_bf16 v169, v204, v204, v169
    v_dot2_f32_bf16 v168, v205, v54, v168
    v_dot2_f32_bf16 v169, v205, v205, v169
    v_dot2_f32_bf16 v168, v206, v54, v168
    v_dot2_f32_bf16 v169, v206, v206, v169
    v_dot2_f32_bf16 v168, v207, v54, v168
    v_dot2_f32_bf16 v169, v207, v207, v169
    v_mfma_f32_16x16x32_bf16 v[108:111], a[0:3], v[184:187], 0
    v_add_u32 v172, s19, v11
    ds_read_b64_tr_b16 a[12:13], v7 offset:12288
    ds_read_b64_tr_b16 a[14:15], v7 offset:12800
    v_mfma_f32_16x16x32_bf16 v[128:131], a[4:7], v[184:187], 0
    ds_read_b64_tr_b16 a[16:17], v7 offset:13312
    ds_read_b64_tr_b16 a[18:19], v7 offset:13824
    ds_read_b64_tr_b16 a[20:21], v7 offset:14336
    ds_read_b64_tr_b16 a[22:23], v7 offset:14848
    v_mfma_f32_16x16x32_bf16 v[148:151], v[184:187], a[8:11], 0
    ds_read_b128 v[208:211], v11 offset:0
    ds_read_b128 v[212:215], v11 offset:4096
    ds_read_b128 v[216:219], v11 offset:8192
    ds_read_b128 v[220:223], v11 offset:12288
    v_mfma_f32_16x16x32_bf16 v[112:115], a[0:3], v[188:191], 0
    ds_read_b128 v[224:227], v11 offset:16384
    ds_read_b128 v[228:231], v172
    buffer_load_dwordx2 v[174:175], v9, s[40:43], 0 offen sc1
    v_mfma_f32_16x16x32_bf16 v[132:135], a[4:7], v[188:191], 0
    s_add_u32 m0, s55, 61440
    s_add_u32 s74, s71, s83
    buffer_load_dwordx4 v6, s[8:11], s74 offen offset:0 lds
    v_mfma_f32_16x16x32_bf16 v[152:155], v[188:191], a[8:11], 0
    buffer_load_dwordx4 v6, s[8:11], s74 offen offset:1024 lds
    v_mfma_f32_16x16x32_bf16 v[116:119], a[0:3], v[192:195], 0
    buffer_load_dwordx4 v6, s[8:11], s74 offen offset:2048 lds
    v_mfma_f32_16x16x32_bf16 v[136:139], a[4:7], v[192:195], 0
    s_add_u32 m0, s68, 0
    s_cmp_lt_u32 s44, 2
    s_cselect_b32 s74, 2146435072, s64
    s_mov_b64 exec, s[86:87]
    buffer_load_dwordx4 v5, s[4:7], s74 offen lds
    s_mov_b64 exec, -1
    v_mfma_f32_16x16x32_bf16 v[156:159], v[192:195], a[8:11], 0
    s_add_u32 m0, s68, 4096
    s_add_u32 s74, s64, 32768
    buffer_load_dwordx4 v5, s[4:7], s74 offen lds
    v_mfma_f32_16x16x32_bf16 v[120:123], a[0:3], v[196:199], 0
    v_mfma_f32_16x16x32_bf16 v[140:143], a[4:7], v[196:199], 0
    v_mfma_f32_16x16x32_bf16 v[160:163], v[196:199], a[8:11], 0
    v_mfma_f32_16x16x32_bf16 v[124:127], a[0:3], v[200:203], 0
    v_mfma_f32_16x16x32_bf16 v[144:147], a[4:7], v[200:203], 0
    v_mfma_f32_16x16x32_bf16 v[164:167], v[200:203], a[8:11], 0
    s_waitcnt lgkmcnt(0)
    v_dot2_f32_bf16 v168, v228, v54, v168
    v_dot2_f32_bf16 v169, v228, v228, v169
    v_dot2_f32_bf16 v168, v229, v54, v168
    v_dot2_f32_bf16 v169, v229, v229, v169
    v_dot2_f32_bf16 v168, v230, v54, v168
    v_dot2_f32_bf16 v169, v230, v230, v169
    v_dot2_f32_bf16 v168, v231, v54, v168
    v_dot2_f32_bf16 v169, v231, v231, v169
    v_mfma_f32_16x16x32_bf16 v[108:111], a[12:15], v[208:211], v[108:111]
    v_add_u32 v172, s19, v12
    ds_read_b64_tr_b16 a[24:25], v7 offset:24576
    ds_read_b64_tr_b16 a[26:27], v7 offset:25088
    v_mfma_f32_16x16x32_bf16 v[128:131], a[16:19], v[208:211], v[128:131]
    ds_read_b64_tr_b16 a[28:29], v7 offset:25600
    ds_read_b64_tr_b16 a[30:31], v7 offset:26112
    ds_read_b64_tr_b16 a[32:33], v7 offset:26624
    ds_read_b64_tr_b16 a[34:35], v7 offset:27136
    v_mfma_f32_16x16x32_bf16 v[148:151], v[208:211], a[20:23], v[148:151]
    ds_read_b128 v[184:187], v12 offset:0
    ds_read_b128 v[188:191], v12 offset:4096
    ds_read_b128 v[192:195], v12 offset:8192
    ds_read_b128 v[196:199], v12 offset:12288
    v_mfma_f32_16x16x32_bf16 v[112:115], a[12:15], v[212:215], v[112:115]
    ds_read_b128 v[200:203], v12 offset:16384
    ds_read_b128 v[204:207], v172
    s_add_u32 m0, s55, 0
    s_add_u32 s74, s71, s84
    buffer_load_dwordx4 v6, s[8:11], s74 offen offset:0 lds
    v_mfma_f32_16x16x32_bf16 v[132:135], a[16:19], v[212:215], v[132:135]
    buffer_load_dwordx4 v6, s[8:11], s74 offen offset:1024 lds
    v_mfma_f32_16x16x32_bf16 v[152:155], v[212:215], a[20:23], v[152:155]
    buffer_load_dwordx4 v6, s[8:11], s74 offen offset:2048 lds
    v_mfma_f32_16x16x32_bf16 v[116:119], a[12:15], v[216:219], v[116:119]
    s_add_u32 m0, s68, 8192
    s_add_u32 s74, s64, 65536
    buffer_load_dwordx4 v5, s[4:7], s74 offen lds
    v_mfma_f32_16x16x32_bf16 v[136:139], a[16:19], v[216:219], v[136:139]
    s_add_u32 m0, s68, 12288
    s_add_u32 s74, s64, 98304
    buffer_load_dwordx4 v5, s[4:7], s74 offen lds
    v_mfma_f32_16x16x32_bf16 v[156:159], v[216:219], a[20:23], v[156:159]
    s_add_u32 m0, s68, 16384
    s_add_u32 s74, s64, 131072
    buffer_load_dwordx4 v5, s[4:7], s74 offen lds
    v_mfma_f32_16x16x32_bf16 v[120:123], a[12:15], v[220:223], v[120:123]
    v_mfma_f32_16x16x32_bf16 v[140:143], a[16:19], v[220:223], v[140:143]
    v_mfma_f32_16x16x32_bf16 v[160:163], v[220:223], a[20:23], v[160:163]
    v_mfma_f32_16x16x32_bf16 v[124:127], a[12:15], v[224:227], v[124:127]
    v_mfma_f32_16x16x32_bf16 v[144:147], a[16:19], v[224:227], v[144:147]
    v_mfma_f32_16x16x32_bf16 v[164:167], v[224:227], a[20:23], v[164:167]
    s_waitcnt vmcnt(14) lgkmcnt(0)
    s_barrier
    v_dot2_f32_bf16 v168, v204, v54, v168
    v_dot2_f32_bf16 v169, v204, v204, v169
    v_dot2_f32_bf16 v168, v205, v54, v168
    v_dot2_f32_bf16 v169, v205, v205, v169
    v_dot2_f32_bf16 v168, v206, v54, v168
    v_dot2_f32_bf16 v169, v206, v206, v169
    v_dot2_f32_bf16 v168, v207, v54, v168
    v_dot2_f32_bf16 v169, v207, v207, v169
    v_mfma_f32_16x16x32_bf16 v[108:111], a[24:27], v[184:187], v[108:111]
    v_add_u32 v172, s19, v13
    ds_read_b64_tr_b16 a[36:37], v7 offset:36864
    ds_read_b64_tr_b16 a[38:39], v7 offset:37376
    v_mfma_f32_16x16x32_bf16 v[128:131], a[28:31], v[184:187], v[128:131]
    ds_read_b64_tr_b16 a[40:41], v7 offset:37888
    ds_read_b64_tr_b16 a[42:43], v7 offset:38400
    ds_read_b64_tr_b16 a[44:45], v7 offset:38912
    ds_read_b64_tr_b16 a[46:47], v7 offset:39424
    v_mfma_f32_16x16x32_bf16 v[148:151], v[184:187], a[32:35], v[148:151]
    ds_read_b128 v[208:211], v13 offset:0
    ds_read_b128 v[212:215], v13 offset:4096
    ds_read_b128 v[216:219], v13 offset:8192
    ds_read_b128 v[220:223], v13 offset:12288
    v_mfma_f32_16x16x32_bf16 v[112:115], a[24:27], v[188:191], v[112:115]
    ds_read_b128 v[224:227], v13 offset:16384
    ds_read_b128 v[228:231], v172
    s_add_u32 m0, s55, 12288
    s_add_u32 s74, s71, s85
    buffer_load_dwordx4 v6, s[8:11], s74 offen offset:0 lds
    v_mfma_f32_16x16x32_bf16 v[132:135], a[28:31], v[188:191], v[132:135]
    buffer_load_dwordx4 v6, s[8:11], s74 offen offset:1024 lds
    v_mfma_f32_16x16x32_bf16 v[152:155], v[188:191], a[32:35], v[152:155]
    buffer_load_dwordx4 v6, s[8:11], s74 offen offset:2048 lds
    v_mfma_f32_16x16x32_bf16 v[116:119], a[24:27], v[192:195], v[116:119]
    s_add_u32 m0, s69, 0
    s_cmp_lt_u32 s44, 2
    s_cselect_b32 s74, 2146435072, s65
    s_mov_b64 exec, s[86:87]
    buffer_load_dwordx4 v5, s[4:7], s74 offen lds
    s_mov_b64 exec, -1
    v_mfma_f32_16x16x32_bf16 v[136:139], a[28:31], v[192:195], v[136:139]
    s_add_u32 m0, s69, 4096
    s_add_u32 s74, s65, 32768
    buffer_load_dwordx4 v5, s[4:7], s74 offen lds
    v_mfma_f32_16x16x32_bf16 v[156:159], v[192:195], a[32:35], v[156:159]
    v_mfma_f32_16x16x32_bf16 v[120:123], a[24:27], v[196:199], v[120:123]
    v_mfma_f32_16x16x32_bf16 v[140:143], a[28:31], v[196:199], v[140:143]
    v_mfma_f32_16x16x32_bf16 v[160:163], v[196:199], a[32:35], v[160:163]
    v_mfma_f32_16x16x32_bf16 v[124:127], a[24:27], v[200:203], v[124:127]
    v_mfma_f32_16x16x32_bf16 v[144:147], a[28:31], v[200:203], v[144:147]
    v_mfma_f32_16x16x32_bf16 v[164:167], v[200:203], a[32:35], v[164:167]
    s_waitcnt lgkmcnt(0)
    v_dot2_f32_bf16 v168, v228, v54, v168
    v_dot2_f32_bf16 v169, v228, v228, v169
    v_dot2_f32_bf16 v168, v229, v54, v168
    v_dot2_f32_bf16 v169, v229, v229, v169
    v_dot2_f32_bf16 v168, v230, v54, v168
    v_dot2_f32_bf16 v169, v230, v230, v169
    v_dot2_f32_bf16 v168, v231, v54, v168
    v_dot2_f32_bf16 v169, v231, v231, v169
    v_mfma_f32_16x16x32_bf16 v[108:111], a[36:39], v[208:211], v[108:111]
    v_add_u32 v172, s19, v14
    ds_read_b64_tr_b16 a[48:49], v7 offset:49152
    ds_read_b64_tr_b16 a[50:51], v7 offset:49664
    v_mfma_f32_16x16x32_bf16 v[128:131], a[40:43], v[208:211], v[128:131]
    ds_read_b64_tr_b16 a[52:53], v7 offset:50176
    ds_read_b64_tr_b16 a[54:55], v7 offset:50688
    ds_read_b64_tr_b16 a[56:57], v7 offset:51200
    ds_read_b64_tr_b16 a[58:59], v7 offset:51712
    v_mfma_f32_16x16x32_bf16 v[148:151], v[208:211], a[44:47], v[148:151]
    ds_read_b128 v[184:187], v14 offset:0
    ds_read_b128 v[188:191], v14 offset:4096
    ds_read_b128 v[192:195], v14 offset:8192
    ds_read_b128 v[196:199], v14 offset:12288
    v_mfma_f32_16x16x32_bf16 v[112:115], a[36:39], v[212:215], v[112:115]
    ds_read_b128 v[200:203], v14 offset:16384
    ds_read_b128 v[204:207], v172
    s_add_u32 m0, s55, 24576
    s_add_u32 s74, s72, s82
    buffer_load_dwordx4 v6, s[8:11], s74 offen offset:0 lds
    v_mfma_f32_16x16x32_bf16 v[132:135], a[40:43], v[212:215], v[132:135]
    buffer_load_dwordx4 v6, s[8:11], s74 offen offset:1024 lds
    v_mfma_f32_16x16x32_bf16 v[152:155], v[212:215], a[44:47], v[152:155]
    buffer_load_dwordx4 v6, s[8:11], s74 offen offset:2048 lds
    v_mfma_f32_16x16x32_bf16 v[116:119], a[36:39], v[216:219], v[116:119]
    s_add_u32 m0, s69, 8192
    s_add_u32 s74, s65, 65536
    buffer_load_dwordx4 v5, s[4:7], s74 offen lds
    v_mfma_f32_16x16x32_bf16 v[136:139], a[40:43], v[216:219], v[136:139]
    s_add_u32 m0, s69, 12288
    s_add_u32 s74, s65, 98304
    buffer_load_dwordx4 v5, s[4:7], s74 offen lds
    v_mfma_f32_16x16x32_bf16 v[156:159], v[216:219], a[44:47], v[156:159]
    s_add_u32 m0, s69, 16384
    s_add_u32 s74, s65, 131072
    buffer_load_dwordx4 v5, s[4:7], s74 offen lds
    v_mfma_f32_16x16x32_bf16 v[120:123], a[36:39], v[220:223], v[120:123]
    v_mfma_f32_16x16x32_bf16 v[140:143], a[40:43], v[220:223], v[140:143]
    v_mfma_f32_16x16x32_bf16 v[160:163], v[220:223], a[44:47], v[160:163]
    v_mfma_f32_16x16x32_bf16 v[124:127], a[36:39], v[224:227], v[124:127]
    v_mfma_f32_16x16x32_bf16 v[144:147], a[40:43], v[224:227], v[144:147]
    v_mfma_f32_16x16x32_bf16 v[164:167], v[224:227], a[44:47], v[164:167]
    s_waitcnt vmcnt(14) lgkmcnt(0)
    s_barrier
    v_dot2_f32_bf16 v168, v204, v54, v168
    v_dot2_f32_bf16 v169, v204, v204, v169
    v_dot2_f32_bf16 v168, v205, v54, v168
    v_dot2_f32_bf16 v169, v205, v205, v169
    v_dot2_f32_bf16 v168, v206, v54, v168
    v_dot2_f32_bf16 v169, v206, v206, v169
    v_dot2_f32_bf16 v168, v207, v54, v168
    v_dot2_f32_bf16 v169, v207, v207, v169
    s_mov_b32 s61, 0
L_ep_4:
    v_readfirstlane_b32 s50, v174
    v_readfirstlane_b32 s51, v175
    s_add_u32 s61, s61, 1
    s_cmp_lg_u32 s50, 0
    s_cbranch_scc1 L_epok_5
    s_cmp_gt_u32 s61, 40000
    s_cbranch_scc1 L_epok_5
    s_sleep 2
    buffer_load_dwordx2 v[174:175], v9, s[40:43], 0 offen sc1
    s_waitcnt vmcnt(0)
    s_branch L_ep_4
L_epok_5:
    v_mov_b32 v36, s50
    v_mov_b32 v37, s51
    s_cmp_lg_u32 s44, 0
    s_cbranch_scc1 L_nf_6
    v_mov_b32 v178, s50
    v_mov_b32 v179, s51
    v_mov_b32 v180, s53
    v_mov_b32 v181, 0
    s_and_b32 s74, s2, 7
    s_lshl_b32 s74, s74, 8
    s_and_b32 s75, s2, 0xf8
    s_add_u32 s74, s74, s75
    s_add_u32 s74, s74, 11423744
    s_lshl_b32 s75, s45, 7
    s_lshl_b32 s76, s46, 4
    s_add_u32 s75, s75, s76
    s_add_u32 s75, s75, 11419648
    s_mov_b64 exec, 1
    buffer_store_dwordx2 v[178:179], v9, s[12:15], s74 offen sc1
    buffer_store_dwordx4 v[178:181], v9, s[12:15], s75 offen sc1
    s_mov_b64 exec, -1
L_nf_6:
    v_mfma_f32_16x16x32_bf16 v[108:111], a[48:51], v[184:187], v[108:111]
    v_add_u32 v172, s19, v15
    ds_read_b64_tr_b16 a[60:61], v7 offset:61440
    ds_read_b64_tr_b16 a[62:63], v7 offset:61952
    v_mfma_f32_16x16x32_bf16 v[128:131], a[52:55], v[184:187], v[128:131]
    ds_read_b64_tr_b16 a[64:65], v7 offset:62464
    ds_read_b64_tr_b16 a[66:67], v7 offset:62976
    ds_read_b64_tr_b16 a[68:69], v7 offset:63488
    ds_read_b64_tr_b16 a[70:71], v7 offset:64000
    v_mfma_f32_16x16x32_bf16 v[148:151], v[184:187], a[56:59], v[148:151]
    ds_read_b128 v[208:211], v15 offset:0
    ds_read_b128 v[212:215], v15 offset:4096
    ds_read_b128 v[216:219], v15 offset:8192
    ds_read_b128 v[220:223], v15 offset:12288
    v_mfma_f32_16x16x32_bf16 v[112:115], a[48:51], v[188:191], v[112:115]
    ds_read_b128 v[224:227], v15 offset:16384
    ds_read_b128 v[228:231], v172
    s_add_u32 m0, s55, 36864
    s_add_u32 s74, s72, s83
    buffer_load_dwordx4 v6, s[8:11], s74 offen offset:0 lds
    v_mfma_f32_16x16x32_bf16 v[132:135], a[52:55], v[188:191], v[132:135]
    buffer_load_dwordx4 v6, s[8:11], s74 offen offset:1024 lds
    v_mfma_f32_16x16x32_bf16 v[152:155], v[188:191], a[56:59], v[152:155]
    buffer_load_dwordx4 v6, s[8:11], s74 offen offset:2048 lds
    v_mfma_f32_16x16x32_bf16 v[116:119], a[48:51], v[192:195], v[116:119]
    v_mfma_f32_16x16x32_bf16 v[136:139], a[52:55], v[192:195], v[136:139]
    v_mfma_f32_16x16x32_bf16 v[156:159], v[192:195], a[56:59], v[156:159]
    v_mfma_f32_16x16x32_bf16 v[120:123], a[48:51], v[196:199], v[120:123]
    v_mfma_f32_16x16x32_bf16 v[140:143], a[52:55], v[196:199], v[140:143]
    v_mfma_f32_16x16x32_bf16 v[160:163], v[196:199], a[56:59], v[160:163]
    v_mfma_f32_16x16x32_bf16 v[124:127], a[48:51], v[200:203], v[124:127]
    v_mfma_f32_16x16x32_bf16 v[144:147], a[52:55], v[200:203], v[144:147]
    v_mfma_f32_16x16x32_bf16 v[164:167], v[200:203], a[56:59], v[164:167]
    s_waitcnt lgkmcnt(0)
    v_dot2_f32_bf16 v168, v228, v54, v168
    v_dot2_f32_bf16 v169, v228, v228, v169
    v_dot2_f32_bf16 v168, v229, v54, v168
    v_dot2_f32_bf16 v169, v229, v229, v169
    v_dot2_f32_bf16 v168, v230, v54, v168
    v_dot2_f32_bf16 v169, v230, v230, v169
    v_dot2_f32_bf16 v168, v231, v54, v168
    v_dot2_f32_bf16 v169, v231, v231, v169
    v_mfma_f32_16x16x32_bf16 v[108:111], a[60:63], v[208:211], v[108:111]
    v_add_u32 v172, s19, v16
    ds_read_b64_tr_b16 a[72:73], v7 offset:0
    ds_read_b64_tr_b16 a[74:75], v7 offset:512
    v_mfma_f32_16x16x32_bf16 v[128:131], a[64:67], v[208:211], v[128:131]
    ds_read_b64_tr_b16 a[76:77], v7 offset:1024
    ds_read_b64_tr_b16 a[78:79], v7 offset:1536
    ds_read_b64_tr_b16 a[80:81], v7 offset:2048
    ds_read_b64_tr_b16 a[82:83], v7 offset:2560
    v_mfma_f32_16x16x32_bf16 v[148:151], v[208:211], a[68:71], v[148:151]
    ds_read_b128 v[184:187], v16 offset:0
    ds_read_b128 v[188:191], v16 offset:4096
    ds_read_b128 v[192:195], v16 offset:8192
    ds_read_b128 v[196:199], v16 offset:12288
    v_mfma_f32_16x16x32_bf16 v[112:115], a[60:63], v[212:215], v[112:115]
    ds_read_b128 v[200:203], v16 offset:16384
    ds_read_b128 v[204:207], v172
    s_add_u32 m0, s55, 49152
    s_add_u32 s74, s72, s84
    buffer_load_dwordx4 v6, s[8:11], s74 offen offset:0 lds
    v_mfma_f32_16x16x32_bf16 v[132:135], a[64:67], v[212:215], v[132:135]
    buffer_load_dwordx4 v6, s[8:11], s74 offen offset:1024 lds
    v_mfma_f32_16x16x32_bf16 v[152:155], v[212:215], a[68:71], v[152:155]
    buffer_load_dwordx4 v6, s[8:11], s74 offen offset:2048 lds
    v_mfma_f32_16x16x32_bf16 v[116:119], a[60:63], v[216:219], v[116:119]
    v_mfma_f32_16x16x32_bf16 v[136:139], a[64:67], v[216:219], v[136:139]
    v_mfma_f32_16x16x32_bf16 v[156:159], v[216:219], a[68:71], v[156:159]
    v_mfma_f32_16x16x32_bf16 v[120:123], a[60:63], v[220:223], v[120:123]
    v_mfma_f32_16x16x32_bf16 v[140:143], a[64:67], v[220:223], v[140:143]
    v_mfma_f32_16x16x32_bf16 v[160:163], v[220:223], a[68:71], v[160:163]
    v_mfma_f32_16x16x32_bf16 v[124:127], a[60:63], v[224:227], v[124:127]
    v_mfma_f32_16x16x32_bf16 v[144:147], a[64:67], v[224:227], v[144:147]
    v_mfma_f32_16x16x32_bf16 v[164:167], v[224:227], a[68:71], v[164:167]
    s_waitcnt vmcnt(9) lgkmcnt(0)
    s_barrier
    v_dot2_f32_bf16 v168, v204, v54, v168
    v_dot2_f32_bf16 v169, v204, v204, v169
    v_dot2_f32_bf16 v168, v205, v54, v168
    v_dot2_f32_bf16 v169, v205, v205, v169
    v_dot2_f32_bf16 v168, v206, v54, v168
    v_dot2_f32_bf16 v169, v206, v206, v169
    v_dot2_f32_bf16 v168, v207, v54, v168
    v_dot2_f32_bf16 v169, v207, v207, v169
    v_mfma_f32_16x16x32_bf16 v[108:111], a[72:75], v[184:187], v[108:111]
    v_add_u32 v172, s19, v17
    ds_read_b64_tr_b16 a[84:85], v7 offset:12288
    ds_read_b64_tr_b16 a[86:87], v7 offset:12800
    v_mfma_f32_16x16x32_bf16 v[128:131], a[76:79], v[184:187], v[128:131]
    ds_read_b64_tr_b16 a[88:89], v7 offset:13312
    ds_read_b64_tr_b16 a[90:91], v7 offset:13824
    ds_read_b64_tr_b16 a[92:93], v7 offset:14336
    ds_read_b64_tr_b16 a[94:95], v7 offset:14848
    v_mfma_f32_16x16x32_bf16 v[148:151], v[184:187], a[80:83], v[148:151]
    ds_read_b128 v[208:211], v17 offset:0
    ds_read_b128 v[212:215], v17 offset:4096
    ds_read_b128 v[216:219], v17 offset:8192
    ds_read_b128 v[220:223], v17 offset:12288
    v_mfma_f32_16x16x32_bf16 v[112:115], a[72:75], v[188:191], v[112:115]
    ds_read_b128 v[224:227], v17 offset:16384
    ds_read_b128 v[228:231], v172
    s_add_u32 m0, s55, 61440
    s_add_u32 s74, s72, s85
    buffer_load_dwordx4 v6, s[8:11], s74 offen offset:0 lds
    v_mfma_f32_16x16x32_bf16 v[132:135], a[76:79], v[188:191], v[132:135]
    buffer_load_dwordx4 v6, s[8:11], s74 offen offset:1024 lds
    v_mfma_f32_16x16x32_bf16 v[152:155], v[188:191], a[80:83], v[152:155]
    buffer_load_dwordx4 v6, s[8:11], s74 offen offset:2048 lds
    v_mfma_f32_16x16x32_bf16 v[116:119], a[72:75], v[192:195], v[116:119]
    v_mfma_f32_16x16x32_bf16 v[136:139], a[76:79], v[192:195], v[136:139]
    v_mfma_f32_16x16x32_bf16 v[156:159], v[192:195], a[80:83], v[156:159]
    v_mfma_f32_16x16x32_bf16 v[120:123], a[72:75], v[196:199], v[120:123]
    v_mfma_f32_16x16x32_bf16 v[140:143], a[76:79], v[196:199], v[140:143]
    v_mfma_f32_16x16x32_bf16 v[160:163], v[196:199], a[80:83], v[160:163]
    v_mfma_f32_16x16x32_bf16 v[124:127], a[72:75], v[200:203], v[124:127]
    v_mfma_f32_16x16x32_bf16 v[144:147], a[76:79], v[200:203], v[144:147]
    v_mfma_f32_16x16x32_bf16 v[164:167], v[200:203], a[80:83], v[164:167]
    s_waitcnt lgkmcnt(0)
    v_dot2_f32_bf16 v168, v228, v54, v168
    v_dot2_f32_bf16 v169, v228, v228, v169
    v_dot2_f32_bf16 v168, v229, v54, v168
    v_dot2_f32_bf16 v169, v229, v229, v169
    v_dot2_f32_bf16 v168, v230, v54, v168
    v_dot2_f32_bf16 v169, v230, v230, v169
    v_dot2_f32_bf16 v168, v231, v54, v168
    v_dot2_f32_bf16 v169, v231, v231, v169
    v_mfma_f32_16x16x32_bf16 v[108:111], a[84:87], v[208:211], v[108:111]
    v_add_u32 v172, s19, v18
    ds_read_b64_tr_b16 a[96:97], v7 offset:24576
    ds_read_b64_tr_b16 a[98:99], v7 offset:25088
    v_mfma_f32_16x16x32_bf16 v[128:131], a[88:91], v[208:211], v[128:131]
    ds_read_b64_tr_b16 a[100:101], v7 offset:25600
    ds_read_b64_tr_b16 a[102:103], v7 offset:26112
    ds_read_b64_tr_b16 a[104:105], v7 offset:26624
    ds_read_b64_tr_b16 a[106:107], v7 offset:27136
    v_mfma_f32_16x16x32_bf16 v[148:151], v[208:211], a[92:95], v[148:151]
    ds_read_b128 v[184:187], v18 offset:0
    ds_read_b128 v[188:191], v18 offset:4096
    ds_read_b128 v[192:195], v18 offset:8192
    ds_read_b128 v[196:199], v18 offset:12288
    v_mfma_f32_16x16x32_bf16 v[112:115], a[84:87], v[212:215], v[112:115]
    ds_read_b128 v[200:203], v18 offset:16384
    ds_read_b128 v[204:207], v172
    s_add_u32 m0, s55, 0
    s_add_u32 s74, s73, s82
    buffer_load_dwordx4 v6, s[8:11], s74 offen offset:0 lds
    v_mfma_f32_16x16x32_bf16 v[132:135], a[88:91], v[212:215], v[132:135]
    buffer_load_dwordx4 v6, s[8:11], s74 offen offset:1024 lds
    v_mfma_f32_16x16x32_bf16 v[152:155], v[212:215], a[92:95], v[152:155]
    buffer_load_dwordx4 v6, s[8:11], s74 offen offset:2048 lds
    v_mfma_f32_16x16x32_bf16 v[116:119], a[84:87], v[216:219], v[116:119]
    s_lshl_b32 s74, s2, 13
    s_lshl_b32 s75, s44, 11
    s_add_u32 s74, s74, s75
    buffer_load_dwordx4 v[240:243], v4, s[32:35], s74 offen
    v_mfma_f32_16x16x32_bf16 v[136:139], a[88:91], v[216:219], v[136:139]
    buffer_load_dwordx4 v[240:243], v4, s[32:35], s74 offen offset:1024
    v_mfma_f32_16x16x32_bf16 v[156:159], v[216:219], a[92:95], v[156:159]
    v_lshlrev_b32 v236, 18, v1
    buffer_load_dword v237, v236, s[12:15], 0 offen
    v_mfma_f32_16x16x32_bf16 v[120:123], a[84:87], v[220:223], v[120:123]
    buffer_load_dword v237, v236, s[36:39], 0 offen
    v_mfma_f32_16x16x32_bf16 v[140:143], a[88:91], v[220:223], v[140:143]
    v_mfma_f32_16x16x32_bf16 v[160:163], v[220:223], a[92:95], v[160:163]
    v_mfma_f32_16x16x32_bf16 v[124:127], a[84:87], v[224:227], v[124:127]
    v_mfma_f32_16x16x32_bf16 v[144:147], a[88:91], v[224:227], v[144:147]
    v_mfma_f32_16x16x32_bf16 v[164:167], v[224:227], a[92:95], v[164:167]
    s_waitcnt vmcnt(10) lgkmcnt(0)
    s_barrier
    v_dot2_f32_bf16 v168, v204, v54, v168
    v_dot2_f32_bf16 v169, v204, v204, v169
    v_dot2_f32_bf16 v168, v205, v54, v168
    v_dot2_f32_bf16 v169, v205, v205, v169
    v_dot2_f32_bf16 v168, v206, v54, v168
    v_dot2_f32_bf16 v169, v206, v206, v169
    v_dot2_f32_bf16 v168, v207, v54, v168
    v_dot2_f32_bf16 v169, v207, v207, v169
    v_mfma_f32_16x16x32_bf16 v[108:111], a[96:99], v[184:187], v[108:111]
    v_add_u32 v172, s19, v19
    ds_read_b64_tr_b16 a[108:109], v7 offset:36864
    ds_read_b64_tr_b16 a[110:111], v7 offset:37376
    v_mfma_f32_16x16x32_bf16 v[128:131], a[100:103], v[184:187], v[128:131]
    ds_read_b64_tr_b16 a[112:113], v7 offset:37888
    ds_read_b64_tr_b16 a[114:115], v7 offset:38400
    ds_read_b64_tr_b16 a[116:117], v7 offset:38912
    ds_read_b64_tr_b16 a[118:119], v7 offset:39424
    v_mfma_f32_16x16x32_bf16 v[148:151], v[184:187], a[104:107], v[148:151]
    ds_read_b128 v[208:211], v19 offset:0
    ds_read_b128 v[212:215], v19 offset:4096
    ds_read_b128 v[216:219], v19 offset:8192
    ds_read_b128 v[220:223], v19 offset:12288
    v_mfma_f32_16x16x32_bf16 v[112:115], a[96:99], v[188:191], v[112:115]
    ds_read_b128 v[224:227], v19 offset:16384
    ds_read_b128 v[228:231], v172
    s_add_u32 m0, s55, 12288
    s_add_u32 s74, s73, s83
    buffer_load_dwordx4 v6, s[8:11], s74 offen offset:0 lds
    v_mfma_f32_16x16x32_bf16 v[132:135], a[100:103], v[188:191], v[132:135]
    buffer_load_dwordx4 v6, s[8:11], s74 offen offset:1024 lds
    v_mfma_f32_16x16x32_bf16 v[152:155], v[188:191], a[104:107], v[152:155]
    buffer_load_dwordx4 v6, s[8:11], s74 offen offset:2048 lds
    v_mfma_f32_16x16x32_bf16 v[116:119], a[96:99], v[192:195], v[116:119]
    s_lshl_b32 s74, s45, 8
    v_lshlrev_b32 v236, 13, v3
    v_lshl_add_u32 v236, v2, 4, v236
    v_mfma_f32_16x16x32_bf16 v[136:139], a[100:103], v[192:195], v[136:139]
    s_add_u32 s74, s74, 11433984
    buffer_load_dword v237, v236, s[12:15], s74 offen sc1
    v_mfma_f32_16x16x32_bf16 v[156:159], v[192:195], a[104:107], v[156:159]
    s_lshl_b32 s74, s45, 13
    s_lshl_b32 s75, s44, 11
    s_add_u32 s74, s74, s75
    v_lshlrev_b32 v236, 7, v2
    v_and_b32 v238, 1, v3
    v_mfma_f32_16x16x32_bf16 v[120:123], a[96:99], v[196:199], v[120:123]
    v_lshl_add_u32 v236, v238, 18, v236
    s_add_u32 s74, s74, 10485760
    buffer_load_dword v237, v236, s[12:15], s74 offen sc1
    v_mfma_f32_16x16x32_bf16 v[140:143], a[100:103], v[196:199], v[140:143]
    v_mfma_f32_16x16x32_bf16 v[160:163], v[196:199], a[104:107], v[160:163]
    v_mfma_f32_16x16x32_bf16 v[124:127], a[96:99], v[200:203], v[124:127]
    v_mfma_f32_16x16x32_bf16 v[144:147], a[100:103], v[200:203], v[144:147]
    v_mfma_f32_16x16x32_bf16 v[164:167], v[200:203], a[104:107], v[164:167]
    s_waitcnt lgkmcnt(0)
    v_dot2_f32_bf16 v168, v228, v54, v168
    v_dot2_f32_bf16 v169, v228, v228, v169
    v_dot2_f32_bf16 v168, v229, v54, v168
    v_dot2_f32_bf16 v169, v229, v229, v169
    v_dot2_f32_bf16 v168, v230, v54, v168
    v_dot2_f32_bf16 v169, v230, v230, v169
    v_dot2_f32_bf16 v168, v231, v54, v168
    v_dot2_f32_bf16 v169, v231, v231, v169
    v_mfma_f32_16x16x32_bf16 v[108:111], a[108:111], v[208:211], v[108:111]
    v_add_u32 v172, s19, v20
    ds_read_b64_tr_b16 a[120:121], v7 offset:49152
    ds_read_b64_tr_b16 a[122:123], v7 offset:49664
    v_mfma_f32_16x16x32_bf16 v[128:131], a[112:115], v[208:211], v[128:131]
    ds_read_b64_tr_b16 a[124:125], v7 offset:50176
    ds_read_b64_tr_b16 a[126:127], v7 offset:50688
    ds_read_b64_tr_b16 a[128:129], v7 offset:51200
    ds_read_b64_tr_b16 a[130:131], v7 offset:51712
    v_mfma_f32_16x16x32_bf16 v[148:151], v[208:211], a[116:119], v[148:151]
    ds_read_b128 v[184:187], v20 offset:0
    ds_read_b128 v[188:191], v20 offset:4096
    ds_read_b128 v[192:195], v20 offset:8192
    ds_read_b128 v[196:199], v20 offset:12288
    v_mfma_f32_16x16x32_bf16 v[112:115], a[108:111], v[212:215], v[112:115]
    ds_read_b128 v[200:203], v20 offset:16384
    ds_read_b128 v[204:207], v172
    s_add_u32 m0, s55, 24576
    s_add_u32 s74, s73, s84
    buffer_load_dwordx4 v6, s[8:11], s74 offen offset:0 lds
    v_mfma_f32_16x16x32_bf16 v[132:135], a[112:115], v[212:215], v[132:135]
    buffer_load_dwordx4 v6, s[8:11], s74 offen offset:1024 lds
    v_mfma_f32_16x16x32_bf16 v[152:155], v[212:215], a[116:119], v[152:155]
    buffer_load_dwordx4 v6, s[8:11], s74 offen offset:2048 lds
    v_mfma_f32_16x16x32_bf16 v[116:119], a[108:111], v[216:219], v[116:119]
    v_mfma_f32_16x16x32_bf16 v[136:139], a[112:115], v[216:219], v[136:139]
    v_mfma_f32_16x16x32_bf16 v[156:159], v[216:219], a[116:119], v[156:159]
    v_mfma_f32_16x16x32_bf16 v[120:123], a[108:111], v[220:223], v[120:123]
    v_mfma_f32_16x16x32_bf16 v[140:143], a[112:115], v[220:223], v[140:143]
    v_mfma_f32_16x16x32_bf16 v[160:163], v[220:223], a[116:119], v[160:163]
    v_mfma_f32_16x16x32_bf16 v[124:127], a[108:111], v[224:227], v[124:127]
    v_mfma_f32_16x16x32_bf16 v[144:147], a[112:115], v[224:227], v[144:147]
    v_mfma_f32_16x16x32_bf16 v[164:167], v[224:227], a[116:119], v[164:167]
    s_waitcnt vmcnt(12) lgkmcnt(0)
    s_barrier
    v_dot2_f32_bf16 v168, v204, v54, v168
    v_dot2_f32_bf16 v169, v204, v204, v169
    v_dot2_f32_bf16 v168, v205, v54, v168
    v_dot2_f32_bf16 v169, v205, v205, v169
    v_dot2_f32_bf16 v168, v206, v54, v168
    v_dot2_f32_bf16 v169, v206, v206, v169
    v_dot2_f32_bf16 v168, v207, v54, v168
    v_dot2_f32_bf16 v169, v207, v207, v169
    v_mfma_f32_16x16x32_bf16 v[108:111], a[120:123], v[184:187], v[108:111]
    v_add_u32 v172, s19, v21
    ds_read_b64_tr_b16 a[132:133], v7 offset:61440
    ds_read_b64_tr_b16 a[134:135], v7 offset:61952
    v_mfma_f32_16x16x32_bf16 v[128:131], a[124:127], v[184:187], v[128:131]
    ds_read_b64_tr_b16 a[136:137], v7 offset:62464
    ds_read_b64_tr_b16 a[138:139], v7 offset:62976
    ds_read_b64_tr_b16 a[140:141], v7 offset:63488
    ds_read_b64_tr_b16 a[142:143], v7 offset:64000
    v_mfma_f32_16x16x32_bf16 v[148:151], v[184:187], a[128:131], v[148:151]
    ds_read_b128 v[208:211], v21 offset:0
    ds_read_b128 v[212:215], v21 offset:4096
    ds_read_b128 v[216:219], v21 offset:8192
    ds_read_b128 v[220:223], v21 offset:12288
    v_mfma_f32_16x16x32_bf16 v[112:115], a[120:123], v[188:191], v[112:115]
    ds_read_b128 v[224:227], v21 offset:16384
    ds_read_b128 v[228:231], v172
    s_add_u32 m0, s55, 36864
    s_add_u32 s74, s73, s85
    buffer_load_dwordx4 v6, s[8:11], s74 offen offset:0 lds
    v_mfma_f32_16x16x32_bf16 v[132:135], a[124:127], v[188:191], v[132:135]
    buffer_load_dwordx4 v6, s[8:11], s74 offen offset:1024 lds
    v_mfma_f32_16x16x32_bf16 v[152:155], v[188:191], a[128:131], v[152:155]
    buffer_load_dwordx4 v6, s[8:11], s74 offen offset:2048 lds
    v_mfma_f32_16x16x32_bf16 v[116:119], a[120:123], v[192:195], v[116:119]
    v_lshrrev_b32 v62, 3, v1
    v_bfe_u32 v63, v62, 1, 1
    v_mfma_f32_16x16x32_bf16 v[136:139], a[124:127], v[192:195], v[136:139]
    s_lshl_b32 s79, s59, 1
    v_or_b32 v63, s79, v63
    v_bfe_u32 v176, v1, 1, 2
    v_mfma_f32_16x16x32_bf16 v[156:159], v[192:195], a[128:131], v[156:159]
    v_xor_b32 v63, v63, v176
    v_lshlrev_b32 v63, 5, v63
    v_mfma_f32_16x16x32_bf16 v[120:123], a[120:123], v[196:199], v[120:123]
    v_and_b32 v176, 1, v1
    v_lshl_add_u32 v63, v176, 4, v63
    v_mfma_f32_16x16x32_bf16 v[140:143], a[124:127], v[196:199], v[140:143]
    v_lshl_add_u32 v176, v62, 10, v63
    s_lshl_b32 s80, s46, 7
    s_lshl_b32 s79, s44, 13
    s_add_u32 s80, s80, s79
    s_lshl_b32 s81, s44, 10
    v_mfma_f32_16x16x32_bf16 v[160:163], v[196:199], a[128:131], v[160:163]
    v_mfma_f32_16x16x32_bf16 v[124:127], a[120:123], v[200:203], v[124:127]
    v_mfma_f32_16x16x32_bf16 v[144:147], a[124:127], v[200:203], v[144:147]
    v_mfma_f32_16x16x32_bf16 v[164:167], v[200:203], a[128:131], v[164:167]
    s_waitcnt lgkmcnt(0)
    v_dot2_f32_bf16 v168, v228, v54, v168
    v_dot2_f32_bf16 v169, v228, v228, v169
    v_dot2_f32_bf16 v168, v229, v54, v168
    v_dot2_f32_bf16 v169, v229, v229, v169
    v_dot2_f32_bf16 v168, v230, v54, v168
    v_dot2_f32_bf16 v169, v230, v230, v169
    v_dot2_f32_bf16 v168, v231, v54, v168
    v_dot2_f32_bf16 v169, v231, v231, v169
    v_mfma_f32_16x16x32_bf16 v[108:111], a[132:135], v[208:211], v[108:111]
    v_add_u32 v172, s19, v22
    ds_read_b64_tr_b16 a[144:145], v7 offset:0
    ds_read_b64_tr_b16 a[146:147], v7 offset:512
    v_mfma_f32_16x16x32_bf16 v[128:131], a[136:139], v[208:211], v[128:131]
    ds_read_b64_tr_b16 a[148:149], v7 offset:1024
    ds_read_b64_tr_b16 a[150:151], v7 offset:1536
    ds_read_b64_tr_b16 a[152:153], v7 offset:2048
    ds_read_b64_tr_b16 a[154:155], v7 offset:2560
    v_mfma_f32_16x16x32_bf16 v[148:151], v[208:211], a[140:143], v[148:151]
    ds_read_b128 v[184:187], v22 offset:0
    ds_read_b128 v[188:191], v22 offset:4096
    ds_read_b128 v[192:195], v22 offset:8192
    ds_read_b128 v[196:199], v22 offset:12288
    v_mfma_f32_16x16x32_bf16 v[112:115], a[132:135], v[212:215], v[112:115]
    ds_read_b128 v[200:203], v22 offset:16384
    ds_read_b128 v[204:207], v172
    v_mfma_f32_16x16x32_bf16 v[132:135], a[136:139], v[212:215], v[132:135]
    v_mfma_f32_16x16x32_bf16 v[152:155], v[212:215], a[140:143], v[152:155]
    v_mfma_f32_16x16x32_bf16 v[116:119], a[132:135], v[216:219], v[116:119]
    v_mfma_f32_16x16x32_bf16 v[136:139], a[136:139], v[216:219], v[136:139]
    v_mfma_f32_16x16x32_bf16 v[156:159], v[216:219], a[140:143], v[156:159]
    v_mfma_f32_16x16x32_bf16 v[120:123], a[132:135], v[220:223], v[120:123]
    v_mfma_f32_16x16x32_bf16 v[140:143], a[136:139], v[220:223], v[140:143]
    v_mfma_f32_16x16x32_bf16 v[160:163], v[220:223], a[140:143], v[160:163]
    v_mfma_f32_16x16x32_bf16 v[124:127], a[132:135], v[224:227], v[124:127]
    v_mfma_f32_16x16x32_bf16 v[144:147], a[136:139], v[224:227], v[144:147]
    v_mfma_f32_16x16x32_bf16 v[164:167], v[224:227], a[140:143], v[164:167]
    s_waitcnt vmcnt(3) lgkmcnt(0)
    s_barrier
    v_dot2_f32_bf16 v168, v204, v54, v168
    v_dot2_f32_bf16 v169, v204, v204, v169
    v_dot2_f32_bf16 v168, v205, v54, v168
    v_dot2_f32_bf16 v169, v205, v205, v169
    v_dot2_f32_bf16 v168, v206, v54, v168
    v_dot2_f32_bf16 v169, v206, v206, v169
    v_dot2_f32_bf16 v168, v207, v54, v168
    v_dot2_f32_bf16 v169, v207, v207, v169
    v_mfma_f32_16x16x32_bf16 v[108:111], a[144:147], v[184:187], v[108:111]
    v_add_u32 v172, s19, v23
    ds_read_b64_tr_b16 a[156:157], v7 offset:12288
    ds_read_b64_tr_b16 a[158:159], v7 offset:12800
    v_mfma_f32_16x16x32_bf16 v[128:131], a[148:151], v[184:187], v[128:131]
    ds_read_b64_tr_b16 a[160:161], v7 offset:13312
    ds_read_b64_tr_b16 a[162:163], v7 offset:13824
    ds_read_b64_tr_b16 a[164:165], v7 offset:14336
    ds_read_b64_tr_b16 a[166:167], v7 offset:14848
    v_mfma_f32_16x16x32_bf16 v[148:151], v[184:187], a[152:155], v[148:151]
    ds_read_b128 v[208:211], v23 offset:0
    ds_read_b128 v[212:215], v23 offset:4096
    ds_read_b128 v[216:219], v23 offset:8192
    ds_read_b128 v[220:223], v23 offset:12288
    v_mfma_f32_16x16x32_bf16 v[112:115], a[144:147], v[188:191], v[112:115]
    ds_read_b128 v[224:227], v23 offset:16384
    ds_read_b128 v[228:231], v172
    s_add_u32 m0, s81, 131072
    s_add_u32 s74, s80, 393216
    buffer_load_dwordx4 v176, s[28:31], s74 offen lds
    v_mfma_f32_16x16x32_bf16 v[132:135], a[148:151], v[188:191], v[132:135]
    s_add_u32 m0, s81, 135168
    s_add_u32 s74, s80, 425984
    buffer_load_dwordx4 v176, s[28:31], s74 offen lds
    v_mfma_f32_16x16x32_bf16 v[152:155], v[188:191], a[152:155], v[152:155]
    s_add_u32 m0, s81, 139264
    s_add_u32 s74, s80, 458752
    buffer_load_dwordx4 v176, s[28:31], s74 offen lds
    v_mfma_f32_16x16x32_bf16 v[116:119], a[144:147], v[192:195], v[116:119]
    v_mfma_f32_16x16x32_bf16 v[136:139], a[148:151], v[192:195], v[136:139]
    v_mfma_f32_16x16x32_bf16 v[156:159], v[192:195], a[152:155], v[156:159]
    v_mfma_f32_16x16x32_bf16 v[120:123], a[144:147], v[196:199], v[120:123]
    v_mfma_f32_16x16x32_bf16 v[140:143], a[148:151], v[196:199], v[140:143]
    v_mfma_f32_16x16x32_bf16 v[160:163], v[196:199], a[152:155], v[160:163]
    v_mfma_f32_16x16x32_bf16 v[124:127], a[144:147], v[200:203], v[124:127]
    v_mfma_f32_16x16x32_bf16 v[144:147], a[148:151], v[200:203], v[144:147]
    v_mfma_f32_16x16x32_bf16 v[164:167], v[200:203], a[152:155], v[164:167]
    s_waitcnt lgkmcnt(0)
    v_dot2_f32_bf16 v168, v228, v54, v168
    v_dot2_f32_bf16 v169, v228, v228, v169
    v_dot2_f32_bf16 v168, v229, v54, v168
    v_dot2_f32_bf16 v169, v229, v229, v169
    v_dot2_f32_bf16 v168, v230, v54, v168
    v_dot2_f32_bf16 v169, v230, v230, v169
    v_dot2_f32_bf16 v168, v231, v54, v168
    v_dot2_f32_bf16 v169, v231, v231, v169
    v_mfma_f32_16x16x32_bf16 v[108:111], a[156:159], v[208:211], v[108:111]
    v_add_u32 v172, s19, v24
    ds_read_b64_tr_b16 a[168:169], v7 offset:24576
    ds_read_b64_tr_b16 a[170:171], v7 offset:25088
    v_mfma_f32_16x16x32_bf16 v[128:131], a[160:163], v[208:211], v[128:131]
    ds_read_b64_tr_b16 a[172:173], v7 offset:25600
    ds_read_b64_tr_b16 a[174:175], v7 offset:26112
    ds_read_b64_tr_b16 a[176:177], v7 offset:26624
    ds_read_b64_tr_b16 a[178:179], v7 offset:27136
    v_mfma_f32_16x16x32_bf16 v[148:151], v[208:211], a[164:167], v[148:151]
    ds_read_b128 v[184:187], v24 offset:0
    ds_read_b128 v[188:191], v24 offset:4096
    ds_read_b128 v[192:195], v24 offset:8192
    ds_read_b128 v[196:199], v24 offset:12288
    v_mfma_f32_16x16x32_bf16 v[112:115], a[156:159], v[212:215], v[112:115]
    ds_read_b128 v[200:203], v24 offset:16384
    ds_read_b128 v[204:207], v172
    s_add_u32 m0, s81, 143360
    s_add_u32 s74, s80, 491520
    buffer_load_dwordx4 v176, s[28:31], s74 offen lds
    v_mfma_f32_16x16x32_bf16 v[132:135], a[160:163], v[212:215], v[132:135]
    s_add_u32 m0, s81, 81920
    s_add_u32 s74, s80, 0
    buffer_load_dwordx4 v176, s[28:31], s74 offen lds
    v_mfma_f32_16x16x32_bf16 v[152:155], v[212:215], a[164:167], v[152:155]
    s_add_u32 m0, s81, 86016
    s_add_u32 s74, s80, 32768
    buffer_load_dwordx4 v176, s[28:31], s74 offen lds
    v_mfma_f32_16x16x32_bf16 v[116:119], a[156:159], v[216:219], v[116:119]
    v_mfma_f32_16x16x32_bf16 v[136:139], a[160:163], v[216:219], v[136:139]
    v_mfma_f32_16x16x32_bf16 v[156:159], v[216:219], a[164:167], v[156:159]
    v_mfma_f32_16x16x32_bf16 v[120:123], a[156:159], v[220:223], v[120:123]
    v_mfma_f32_16x16x32_bf16 v[140:143], a[160:163], v[220:223], v[140:143]
    v_mfma_f32_16x16x32_bf16 v[160:163], v[220:223], a[164:167], v[160:163]
    v_mfma_f32_16x16x32_bf16 v[124:127], a[156:159], v[224:227], v[124:127]
    v_mfma_f32_16x16x32_bf16 v[144:147], a[160:163], v[224:227], v[144:147]
    v_mfma_f32_16x16x32_bf16 v[164:167], v[224:227], a[164:167], v[164:167]
    s_waitcnt vmcnt(6) lgkmcnt(0)
    s_barrier
    v_dot2_f32_bf16 v168, v204, v54, v168
    v_dot2_f32_bf16 v169, v204, v204, v169
    v_dot2_f32_bf16 v168, v205, v54, v168
    v_dot2_f32_bf16 v169, v205, v205, v169
    v_dot2_f32_bf16 v168, v206, v54, v168
    v_dot2_f32_bf16 v169, v206, v206, v169
    v_dot2_f32_bf16 v168, v207, v54, v168
    v_dot2_f32_bf16 v169, v207, v207, v169
    v_mfma_f32_16x16x32_bf16 v[108:111], a[168:171], v[184:187], v[108:111]
    v_add_u32 v172, s19, v25
    ds_read_b64_tr_b16 a[180:181], v7 offset:36864
    ds_read_b64_tr_b16 a[182:183], v7 offset:37376
    v_mfma_f32_16x16x32_bf16 v[128:131], a[172:175], v[184:187], v[128:131]
    ds_read_b64_tr_b16 a[184:185], v7 offset:37888
    ds_read_b64_tr_b16 a[186:187], v7 offset:38400
    ds_read_b64_tr_b16 a[188:189], v7 offset:38912
    ds_read_b64_tr_b16 a[190:191], v7 offset:39424
    v_mfma_f32_16x16x32_bf16 v[148:151], v[184:187], a[176:179], v[148:151]
    ds_read_b128 v[208:211], v25 offset:0
    ds_read_b128 v[212:215], v25 offset:4096
    ds_read_b128 v[216:219], v25 offset:8192
    ds_read_b128 v[220:223], v25 offset:12288
    v_mfma_f32_16x16x32_bf16 v[112:115], a[168:171], v[188:191], v[112:115]
    ds_read_b128 v[224:227], v25 offset:16384
    ds_read_b128 v[228:231], v172
    s_add_u32 m0, s81, 90112
    s_add_u32 s74, s80, 65536
    buffer_load_dwordx4 v176, s[28:31], s74 offen lds
    v_mfma_f32_16x16x32_bf16 v[132:135], a[172:175], v[188:191], v[132:135]
    s_add_u32 m0, s81, 94208
    s_add_u32 s74, s80, 98304
    buffer_load_dwordx4 v176, s[28:31], s74 offen lds
    v_mfma_f32_16x16x32_bf16 v[152:155], v[188:191], a[176:179], v[152:155]
    s_add_u32 m0, s81, 98304
    s_add_u32 s74, s80, 131072
    buffer_load_dwordx4 v176, s[28:31], s74 offen lds
    v_mfma_f32_16x16x32_bf16 v[116:119], a[168:171], v[192:195], v[116:119]
    v_mfma_f32_16x16x32_bf16 v[136:139], a[172:175], v[192:195], v[136:139]
    v_mfma_f32_16x16x32_bf16 v[156:159], v[192:195], a[176:179], v[156:159]
    v_mfma_f32_16x16x32_bf16 v[120:123], a[168:171], v[196:199], v[120:123]
    v_mfma_f32_16x16x32_bf16 v[140:143], a[172:175], v[196:199], v[140:143]
    v_mfma_f32_16x16x32_bf16 v[160:163], v[196:199], a[176:179], v[160:163]
    v_mfma_f32_16x16x32_bf16 v[124:127], a[168:171], v[200:203], v[124:127]
    v_mfma_f32_16x16x32_bf16 v[144:147], a[172:175], v[200:203], v[144:147]
    v_mfma_f32_16x16x32_bf16 v[164:167], v[200:203], a[176:179], v[164:167]
    s_waitcnt lgkmcnt(0)
    v_dot2_f32_bf16 v168, v228, v54, v168
    v_dot2_f32_bf16 v169, v228, v228, v169
    v_dot2_f32_bf16 v168, v229, v54, v168
    v_dot2_f32_bf16 v169, v229, v229, v169
    v_dot2_f32_bf16 v168, v230, v54, v168
    v_dot2_f32_bf16 v169, v230, v230, v169
    v_dot2_f32_bf16 v168, v231, v54, v168
    v_dot2_f32_bf16 v169, v231, v231, v169
    v_mfma_f32_16x16x32_bf16 v[108:111], a[180:183], v[208:211], v[108:111]
    s_lshl_b32 s82, s45, 7
    s_add_u32 s82, s82, 11419648
    v_and_b32 v62, 0x70, v4
    buffer_load_dwordx4 v[178:181], v62, s[12:15], s82 offen sc1
    v_mfma_f32_16x16x32_bf16 v[128:131], a[184:187], v[208:211], v[128:131]
    s_lshr_b32 s83, s2, 5
    s_lshl_b32 s83, s83, 8
    s_add_u32 s83, s83, 11423744
    v_and_b32 v63, 0xf8, v35
    buffer_load_dwordx2 v[182:183], v63, s[12:15], s83 offen sc1
    v_mfma_f32_16x16x32_bf16 v[148:151], v[208:211], a[188:191], v[148:151]
    s_add_u32 m0, s81, 102400
    s_add_u32 s74, s80, 163840
    buffer_load_dwordx4 v176, s[28:31], s74 offen lds
    v_mfma_f32_16x16x32_bf16 v[112:115], a[180:183], v[212:215], v[112:115]
    s_add_u32 m0, s81, 106496
    s_add_u32 s74, s80, 196608
    buffer_load_dwordx4 v176, s[28:31], s74 offen lds
    v_mfma_f32_16x16x32_bf16 v[132:135], a[184:187], v[212:215], v[132:135]
    s_add_u32 m0, s81, 110592
    s_add_u32 s74, s80, 229376
    buffer_load_dwordx4 v176, s[28:31], s74 offen lds
    v_mfma_f32_16x16x32_bf16 v[152:155], v[212:215], a[188:191], v[152:155]
    v_mfma_f32_16x16x32_bf16 v[116:119], a[180:183], v[216:219], v[116:119]
    v_mfma_f32_16x16x32_bf16 v[136:139], a[184:187], v[216:219], v[136:139]
    v_mfma_f32_16x16x32_bf16 v[156:159], v[216:219], a[188:191], v[156:159]
    v_mfma_f32_16x16x32_bf16 v[120:123], a[180:183], v[220:223], v[120:123]
    v_mfma_f32_16x16x32_bf16 v[140:143], a[184:187], v[220:223], v[140:143]
    v_mfma_f32_16x16x32_bf16 v[160:163], v[220:223], a[188:191], v[160:163]
    v_mfma_f32_16x16x32_bf16 v[124:127], a[180:183], v[224:227], v[124:127]
    v_mfma_f32_16x16x32_bf16 v[144:147], a[184:187], v[224:227], v[144:147]
    v_mfma_f32_16x16x32_bf16 v[164:167], v[224:227], a[188:191], v[164:167]
    v_lshrrev_b32 v72, 5, v1
    s_lshl_b32 s74, s44, 1
    s_add_u32 s74, s74, 8
    v_add_u32 v72, s74, v72
    v_lshlrev_b32 v72, 8, v72
    v_lshl_add_u32 v72, v2, 4, v72
    v_and_b32 v73, 1, v3
    v_mul_u32_u24 v73, 20480, v73
    v_add_u32 v72, v72, v73
    ds_read_b128 v[64:67], v72 offset:0
    ds_read_b128 v[68:71], v72 offset:40960
    v_mov_b32 v170, 0
    v_mov_b32 v171, 0
    v_lshlrev_b32 v74, 2, v2
    v_mov_b32_dpp v26, v108 row_newbcast:0 row_mask:0xf bank_mask:0xf
    v_mov_b32_dpp v30, v128 row_newbcast:0 row_mask:0xf bank_mask:0xf
    v_mov_b32_dpp v27, v109 row_newbcast:0 row_mask:0xf bank_mask:0xf
    v_mov_b32_dpp v31, v129 row_newbcast:0 row_mask:0xf bank_mask:0xf
    v_mov_b32_dpp v28, v110 row_newbcast:0 row_mask:0xf bank_mask:0xf
    v_mov_b32_dpp v32, v130 row_newbcast:0 row_mask:0xf bank_mask:0xf
    v_mov_b32_dpp v29, v111 row_newbcast:0 row_mask:0xf bank_mask:0xf
    v_mov_b32_dpp v33, v131 row_newbcast:0 row_mask:0xf bank_mask:0xf
    ds_bpermute_b32 v34, v74, v148
    s_waitcnt lgkmcnt(0)
    s_barrier
    v_and_b32 v104, 0x70, v4
    v_and_b32 v105, 0xf8, v35
    s_waitcnt vmcnt(3)
    s_mov_b32 s61, 0
L_phl_7:
    v_xor_b32 v106, s50, v178
    v_xor_b32 v107, s51, v179
    v_or_b32 v106, v106, v107
    v_xor_b32 v107, s50, v182
    v_or_b32 v106, v106, v107
    v_xor_b32 v107, s51, v183
    v_or_b32 v106, v106, v107
    v_cmp_ne_u32 vcc, 0, v106
    s_add_u32 s61, s61, 1
    s_cmp_gt_u32 s61, 40000
    s_cbranch_scc1 L_phld_8
    s_nop 1
    s_cbranch_vccz L_phld_8
    s_sleep 1
    buffer_load_dwordx4 v[178:181], v104, s[12:15], s82 offen sc1
    buffer_load_dwordx2 v[182:183], v105, s[12:15], s83 offen sc1
    s_waitcnt vmcnt(0)
    s_branch L_phl_7
L_phld_8:
    v_cmp_ne_u32 vcc, s53, v180
    s_lshl_b32 s77, s59, 11
    s_add_u32 s78, s57, s77
    s_add_u32 s78, s78, 6291456
    s_add_u32 m0, s58, s77
    s_nop 0
    buffer_load_dwordx4 v4, s[12:15], s78 offen sc1 lds
    buffer_load_dwordx4 v4, s[12:15], s78 offen offset:1024 sc1 lds
    s_cmp_eq_u64 vcc, 0
    s_cselect_b32 s52, 1, 0
    s_lshl_b32 s77, s59, 1
    s_add_u32 s77, s77, 0
    s_mul_i32 s79, s77, 4160
    s_add_u32 s79, s79, s58
    s_add_u32 s84, s79, 4640
    s_lshl_b32 s77, s77, 1
    s_add_u32 s86, s57, s77
    s_lshl_b32 s77, s59, 1
    s_add_u32 s77, s77, 1
    s_mul_i32 s79, s77, 4160
    s_add_u32 s79, s79, s58
    s_add_u32 s85, s79, 4640
    s_lshl_b32 s77, s77, 1
    s_add_u32 s87, s57, s77
    v_add_u32 v185, v2, v3
    v_subrev_u32 v185, 16, v185
    v_max_i32 v74, 0, v185
    v_lshlrev_b32 v74, 1, v74
    buffer_load_ushort v184, v74, s[32:35], s57 offen
    v_dot2_f32_bf16 v170, v64, v54, v170
    v_dot2_f32_bf16 v171, v64, v64, v171
    v_dot2_f32_bf16 v170, v65, v54, v170
    v_dot2_f32_bf16 v171, v65, v65, v171
    v_dot2_f32_bf16 v170, v66, v54, v170
    v_dot2_f32_bf16 v171, v66, v66, v171
    v_dot2_f32_bf16 v170, v67, v54, v170
    v_dot2_f32_bf16 v171, v67, v67, v171
    v_dot2_f32_bf16 v170, v68, v54, v170
    v_dot2_f32_bf16 v171, v68, v68, v171
    v_dot2_f32_bf16 v170, v69, v54, v170
    v_dot2_f32_bf16 v171, v69, v69, v171
    s_mov_b32 m0, s84
    s_nop 0
    buffer_load_dwordx4 v4, s[32:35], s86 offen offset:0 lds
    v_dot2_f32_bf16 v170, v70, v54, v170
    v_dot2_f32_bf16 v171, v70, v70, v171
    v_dot2_f32_bf16 v170, v71, v54, v170
    v_dot2_f32_bf16 v171, v71, v71, v171
    s_nop 2
    v_add_f32_dpp v170, v170, v170 row_ror:8 row_mask:0xf bank_mask:0xf
    v_add_f32_dpp v171, v171, v171 row_ror:8 row_mask:0xf bank_mask:0xf
    s_nop 0
    v_add_f32_dpp v170, v170, v170 row_ror:4 row_mask:0xf bank_mask:0xf
    v_add_f32_dpp v171, v171, v171 row_ror:4 row_mask:0xf bank_mask:0xf
    s_nop 0
    v_add_f32_dpp v170, v170, v170 row_ror:2 row_mask:0xf bank_mask:0xf
    s_mov_b32 m0, s84
    s_nop 0
    buffer_load_dwordx4 v4, s[32:35], s86 offen offset:1024 lds
    v_add_f32_dpp v171, v171, v171 row_ror:2 row_mask:0xf bank_mask:0xf
    s_nop 0
    v_add_f32_dpp v170, v170, v170 row_ror:1 row_mask:0xf bank_mask:0xf
    v_add_f32_dpp v171, v171, v171 row_ror:1 row_mask:0xf bank_mask:0xf
    s_nop 0
    v_mov_b32 v72, v168
    v_mov_b32 v73, v169
    v_mov_b32 v74, v170
    v_mov_b32 v75, v171
    s_nop 0
    v_permlane16_swap_b32 v168, v72
    v_permlane16_swap_b32 v169, v73
    s_mov_b32 m0, s84
    s_nop 0
    buffer_load_dwordx4 v4, s[32:35], s86 offen offset:2048 lds
    v_permlane16_swap_b32 v170, v74
    v_permlane16_swap_b32 v171, v75
    s_nop 0
    v_add_f32 v168, v168, v72
    v_add_f32 v169, v169, v73
    v_add_f32 v170, v170, v74
    v_add_f32 v171, v171, v75
    v_mov_b32 v72, v168
    v_mov_b32 v73, v169
    s_nop 0
    v_permlane32_swap_b32 v168, v72
    v_permlane32_swap_b32 v169, v73
    s_mov_b32 m0, s84
    s_nop 0
    buffer_load_dwordx4 v4, s[32:35], s86 offen offset:3072 lds
    s_nop 0
    v_add_f32 v168, v168, v72
    v_add_f32 v169, v169, v73
    v_mul_f32 v168, 0x3b000000, v168
    v_mul_f32 v170, 0x3b000000, v170
    v_mul_f32 v169, 0x3b000000, v169
    v_mul_f32 v171, 0x3b000000, v171
    v_fma_f32 v169, -v168, v168, v169
    v_fma_f32 v171, -v170, v170, v171
    v_max_f32 v169, 0, v169
    v_max_f32 v171, 0, v171
    v_cvt_pk_bf16_f32 v72, v168, v169
    s_mov_b32 m0, s85
    s_nop 0
    buffer_load_dwordx4 v4, s[32:35], s87 offen offset:0 lds
    v_cvt_pk_bf16_f32 v73, v170, v171
    v_lshlrev_b32 v168, 16, v72
    v_lshlrev_b32 v170, 16, v73
    v_and_b32 v169, 0xffff0000, v72
    v_and_b32 v171, 0xffff0000, v73
    v_add_f32 v169, 0x3727c5ac, v169
    v_add_f32 v171, 0x3727c5ac, v171
    v_cvt_pk_bf16_f32 v169, v169, v169
    v_cvt_pk_bf16_f32 v171, v171, v171
    v_lshlrev_b32 v169, 16, v169
    v_lshlrev_b32 v171, 16, v171
    v_sqrt_f32 v169, v169
    s_mov_b32 m0, s85
    s_nop 0
    buffer_load_dwordx4 v4, s[32:35], s87 offen offset:1024 lds
    v_sqrt_f32 v171, v171
    s_nop 0
    v_cvt_pk_bf16_f32 v169, v169, v169
    v_cvt_pk_bf16_f32 v171, v171, v171
    v_lshlrev_b32 v169, 16, v169
    v_lshlrev_b32 v171, 16, v171
    v_rcp_f32 v169, v169
    v_rcp_f32 v171, v171
    s_nop 0
    v_lshlrev_b32 v72, 3, v2
    s_lshr_b32 s75, s19, 5
    s_add_u32 s75, s75, 155648
    s_mov_b32 m0, s85
    s_nop 0
    buffer_load_dwordx4 v4, s[32:35], s87 offen offset:2048 lds
    v_add_u32 v73, s75, v72
    ds_write_b64 v73, v[168:169]
    v_lshrrev_b32 v73, 5, v1
    v_lshlrev_b32 v73, 3, v73
    s_lshl_b32 s75, s44, 4
    s_add_u32 s75, s75, 155712
    v_add_u32 v73, s75, v73
    ds_write_b64 v73, v[170:171]
    v_and_b32 v73, 0x38, v72
    v_add_u32 v73, 155648, v73
    v_mov_b32 v74, 0
    v_mov_b32 v75, 1.0
    s_mov_b32 m0, s85
    s_nop 0
    buffer_load_dwordx4 v4, s[32:35], s87 offen offset:3072 lds
    ds_write_b64 v73, v[74:75]
    v_add_u32 v72, 155648, v72
    s_waitcnt lgkmcnt(0)
    s_barrier
    ds_read_b64 v[94:95], v72 offset:0
    ds_read_b64 v[96:97], v72 offset:128
    ds_read_b64 v[98:99], v72 offset:256
    ds_read_b64 v[100:101], v72 offset:384
    ds_read_b64 v[102:103], v72 offset:512
    v_lshlrev_b32 v62, 5, v3
    v_add_u32 v62, 155648, v62
    ds_read_b128 v[196:199], v62 offset:0
    ds_read_b128 v[200:203], v62 offset:16
    ds_read_b128 v[204:207], v62 offset:128
    ds_read_b128 v[208:211], v62 offset:144
    ds_read_b128 v[212:215], v62 offset:256
    ds_read_b128 v[216:219], v62 offset:272
    ds_read_b128 v[220:223], v62 offset:384
    ds_read_b128 v[224:227], v62 offset:400
    ds_read_b128 v[228:231], v62 offset:512
    ds_read_b128 v[232:235], v62 offset:528
    s_waitcnt lgkmcnt(0)
    s_mov_b32 s17, 0x3eb8aa3b
    v_pk_fma_f32 v[128:129], v[30:31], v[94:95], v[128:129] op_sel_hi:[1,0,1] neg_lo:[0,1,0] neg_hi:[0,1,0]
    v_pk_fma_f32 v[130:131], v[32:33], v[94:95], v[130:131] op_sel_hi:[1,0,1] neg_lo:[0,1,0] neg_hi:[0,1,0]
    v_pk_mul_f32 v[128:129], v[128:129], v[94:95] op_sel:[0,1]
    v_pk_mul_f32 v[130:131], v[130:131], v[94:95] op_sel:[0,1]
    v_cvt_pk_bf16_f32 v74, v128, v129
    v_cvt_pk_bf16_f32 v75, v130, v131
    v_fma_f32 v148, -v196, v34, v148
    v_fma_f32 v149, -v198, v34, v149
    v_fma_f32 v150, -v200, v34, v150
    v_fma_f32 v151, -v202, v34, v151
    v_mul_f32 v148, v197, v148
    v_mul_f32 v149, v199, v149
    v_mul_f32 v150, v201, v150
    v_mul_f32 v151, v203, v151
    v_cvt_pk_bf16_f32 v84, v148, v149
    v_cvt_pk_bf16_f32 v85, v150, v151
    s_add_u32 m0, s81, 114688
    s_add_u32 s74, s80, 262144
    buffer_load_dwordx4 v176, s[28:31], s74 offen lds
    v_pk_fma_f32 v[112:113], v[26:27], v[96:97], v[112:113] op_sel_hi:[1,0,1] neg_lo:[0,1,0] neg_hi:[0,1,0]
    v_pk_fma_f32 v[114:115], v[28:29], v[96:97], v[114:115] op_sel_hi:[1,0,1] neg_lo:[0,1,0] neg_hi:[0,1,0]
    v_pk_mul_f32 v[112:113], v[112:113], v[96:97] op_sel:[0,1]
    v_pk_mul_f32 v[114:115], v[114:115], v[96:97] op_sel:[0,1]
    v_cvt_pk_bf16_f32 v66, v112, v113
    v_cvt_pk_bf16_f32 v67, v114, v115
    v_pk_fma_f32 v[132:133], v[30:31], v[96:97], v[132:133] op_sel_hi:[1,0,1] neg_lo:[0,1,0] neg_hi:[0,1,0]
    v_pk_fma_f32 v[134:135], v[32:33], v[96:97], v[134:135] op_sel_hi:[1,0,1] neg_lo:[0,1,0] neg_hi:[0,1,0]
    v_pk_mul_f32 v[132:133], v[132:133], v[96:97] op_sel:[0,1]
    v_pk_mul_f32 v[134:135], v[134:135], v[96:97] op_sel:[0,1]
    v_cvt_pk_bf16_f32 v76, v132, v133
    v_cvt_pk_bf16_f32 v77, v134, v135
    v_fma_f32 v152, -v204, v34, v152
    v_fma_f32 v153, -v206, v34, v153
    v_fma_f32 v154, -v208, v34, v154
    v_fma_f32 v155, -v210, v34, v155
    s_add_u32 m0, s81, 118784
    s_add_u32 s74, s80, 294912
    buffer_load_dwordx4 v176, s[28:31], s74 offen lds
    v_mul_f32 v152, v205, v152
    v_mul_f32 v153, v207, v153
    v_mul_f32 v154, v209, v154
    v_mul_f32 v155, v211, v155
    v_cvt_pk_bf16_f32 v86, v152, v153
    v_cvt_pk_bf16_f32 v87, v154, v155
    v_pk_fma_f32 v[116:117], v[26:27], v[98:99], v[116:117] op_sel_hi:[1,0,1] neg_lo:[0,1,0] neg_hi:[0,1,0]
    v_pk_fma_f32 v[118:119], v[28:29], v[98:99], v[118:119] op_sel_hi:[1,0,1] neg_lo:[0,1,0] neg_hi:[0,1,0]
    v_pk_mul_f32 v[116:117], v[116:117], v[98:99] op_sel:[0,1]
    v_pk_mul_f32 v[118:119], v[118:119], v[98:99] op_sel:[0,1]
    v_cvt_pk_bf16_f32 v68, v116, v117
    v_cvt_pk_bf16_f32 v69, v118, v119
    v_pk_fma_f32 v[136:137], v[30:31], v[98:99], v[136:137] op_sel_hi:[1,0,1] neg_lo:[0,1,0] neg_hi:[0,1,0]
    v_pk_fma_f32 v[138:139], v[32:33], v[98:99], v[138:139] op_sel_hi:[1,0,1] neg_lo:[0,1,0] neg_hi:[0,1,0]
    v_pk_mul_f32 v[136:137], v[136:137], v[98:99] op_sel:[0,1]
    v_pk_mul_f32 v[138:139], v[138:139], v[98:99] op_sel:[0,1]
    s_add_u32 m0, s81, 122880
    s_add_u32 s74, s80, 327680
    buffer_load_dwordx4 v176, s[28:31], s74 offen lds
    v_cvt_pk_bf16_f32 v78, v136, v137
    v_cvt_pk_bf16_f32 v79, v138, v139
    v_fma_f32 v156, -v212, v34, v156
    v_fma_f32 v157, -v214, v34, v157
    v_fma_f32 v158, -v216, v34, v158
    v_fma_f32 v159, -v218, v34, v159
    v_mul_f32 v156, v213, v156
    v_mul_f32 v157, v215, v157
    v_mul_f32 v158, v217, v158
    v_mul_f32 v159, v219, v159
    v_cvt_pk_bf16_f32 v88, v156, v157
    v_cvt_pk_bf16_f32 v89, v158, v159
    v_pk_fma_f32 v[120:121], v[26:27], v[100:101], v[120:121] op_sel_hi:[1,0,1] neg_lo:[0,1,0] neg_hi:[0,1,0]
    v_pk_fma_f32 v[122:123], v[28:29], v[100:101], v[122:123] op_sel_hi:[1,0,1] neg_lo:[0,1,0] neg_hi:[0,1,0]
    v_pk_mul_f32 v[120:121], v[120:121], v[100:101] op_sel:[0,1]
    v_pk_mul_f32 v[122:123], v[122:123], v[100:101] op_sel:[0,1]
    s_add_u32 m0, s81, 126976
    s_add_u32 s74, s80, 360448
    buffer_load_dwordx4 v176, s[28:31], s74 offen lds
    v_cvt_pk_bf16_f32 v70, v120, v121
    v_cvt_pk_bf16_f32 v71, v122, v123
    v_pk_fma_f32 v[140:141], v[30:31], v[100:101], v[140:141] op_sel_hi:[1,0,1] neg_lo:[0,1,0] neg_hi:[0,1,0]
    v_pk_fma_f32 v[142:143], v[32:33], v[100:101], v[142:143] op_sel_hi:[1,0,1] neg_lo:[0,1,0] neg_hi:[0,1,0]
    v_pk_mul_f32 v[140:141], v[140:141], v[100:101] op_sel:[0,1]
    v_pk_mul_f32 v[142:143], v[142:143], v[100:101] op_sel:[0,1]
    v_cvt_pk_bf16_f32 v80, v140, v141
    v_cvt_pk_bf16_f32 v81, v142, v143
    v_fma_f32 v160, -v220, v34, v160
    v_fma_f32 v161, -v222, v34, v161
    v_fma_f32 v162, -v224, v34, v162
    v_fma_f32 v163, -v226, v34, v163
    v_mul_f32 v160, v221, v160
    v_mul_f32 v161, v223, v161
    v_mul_f32 v162, v225, v162
    v_mul_f32 v163, v227, v163
    v_cvt_pk_bf16_f32 v90, v160, v161
    v_cvt_pk_bf16_f32 v91, v162, v163
    v_pk_fma_f32 v[124:125], v[26:27], v[102:103], v[124:125] op_sel_hi:[1,0,1] neg_lo:[0,1,0] neg_hi:[0,1,0]
    v_pk_fma_f32 v[126:127], v[28:29], v[102:103], v[126:127] op_sel_hi:[1,0,1] neg_lo:[0,1,0] neg_hi:[0,1,0]
    v_pk_mul_f32 v[124:125], v[124:125], v[102:103] op_sel:[0,1]
    v_pk_mul_f32 v[126:127], v[126:127], v[102:103] op_sel:[0,1]
    v_cvt_pk_bf16_f32 v72, v124, v125
    v_cvt_pk_bf16_f32 v73, v126, v127
    v_pk_fma_f32 v[144:145], v[30:31], v[102:103], v[144:145] op_sel_hi:[1,0,1] neg_lo:[0,1,0] neg_hi:[0,1,0]
    v_pk_fma_f32 v[146:147], v[32:33], v[102:103], v[146:147] op_sel_hi:[1,0,1] neg_lo:[0,1,0] neg_hi:[0,1,0]
    v_pk_mul_f32 v[144:145], v[144:145], v[102:103] op_sel:[0,1]
    v_pk_mul_f32 v[146:147], v[146:147], v[102:103] op_sel:[0,1]
    v_cvt_pk_bf16_f32 v82, v144, v145
    v_cvt_pk_bf16_f32 v83, v146, v147
    v_fma_f32 v164, -v228, v34, v164
    v_fma_f32 v165, -v230, v34, v165
    v_fma_f32 v166, -v232, v34, v166
    v_fma_f32 v167, -v234, v34, v167
    v_mul_f32 v164, v229, v164
    v_mul_f32 v165, v231, v165
    v_mul_f32 v166, v233, v166
    v_mul_f32 v167, v235, v167
    v_cvt_pk_bf16_f32 v92, v164, v165
    v_cvt_pk_bf16_f32 v93, v166, v167
    v_add_u32 v62, s58, v35
    v_mov_b32 v96, 0
    v_mov_b32 v97, 0
    ds_write_b64 v62, v[96:97] offset:4096
    v_mul_u32_u24 v98, 4160, v3
    v_lshl_add_u32 v98, v2, 1, v98
    s_add_u32 s79, s58, 4608
    v_add_u32 v98, s79, v98
    v_cmp_gt_i32 vcc, 0, v185
    v_add_u32 v94, 1, v2
    v_and_b32 v95, 3, v94
    v_mul_u32_u24 v95, 4160, v95
    v_and_b32 v94, 0x1c, v94
    v_lshl_add_u32 v95, v94, 1, v95
    v_lshl_add_u32 v95, v3, 4, v95
    s_lshl_b32 s77, s59, 8
    s_add_u32 s77, s77, s58
    s_add_u32 s79, s77, 4608
    v_add_u32 v94, s79, v95
    v_lshlrev_b32 v95, 5, v2
    v_sub_u32 v95, 480, v95
    v_lshl_add_u32 v95, v3, 4, v95
    v_add_u32 v95, s77, v95
    s_waitcnt vmcnt(4)
    v_cndmask_b32 v184, v184, 0, vcc
    ds_write_b16 v98, v184
    s_waitcnt lgkmcnt(0)
    s_barrier
    ds_read_b128 v[168:171], v95 offset:3584
    ds_read_b64 v[136:137], v94 offset:0
    ds_read_b64 v[138:139], v94 offset:8
    ds_read_b128 v[172:175], v95 offset:3072
    ds_read_b64 v[140:141], v94 offset:512
    ds_read_b64 v[142:143], v94 offset:520
    ds_read_b128 v[176:179], v95 offset:2560
    ds_read_b64 v[144:145], v94 offset:1024
    ds_read_b64 v[146:147], v94 offset:1032
    ds_read_b128 v[180:183], v95 offset:2048
    ds_read_b64 v[148:149], v94 offset:1536
    ds_read_b64 v[150:151], v94 offset:1544
    ds_read_b128 v[184:187], v95 offset:1536
    ds_read_b64 v[152:153], v94 offset:2048
    ds_read_b64 v[154:155], v94 offset:2056
    ds_read_b128 v[188:191], v95 offset:1024
    ds_read_b64 v[156:157], v94 offset:2560
    ds_read_b64 v[158:159], v94 offset:2568
    ds_read_b128 v[192:195], v95 offset:512
    ds_read_b64 v[160:161], v94 offset:3072
    ds_read_b64 v[162:163], v94 offset:3080
    ds_read_b128 v[196:199], v95 offset:0
    ds_read_b64 v[164:165], v94 offset:3584
    ds_read_b64 v[166:167], v94 offset:3592
    s_waitcnt lgkmcnt(0)
    v_mfma_f32_16x16x32_bf16 v[104:107], v[136:139], v[168:171], 0
    ds_read_b128 a[224:227], v95 offset:3648
    v_and_b32 v236, 0xf8, v35
    s_lshl_b32 s74, s46, 2
    s_add_u32 s74, s74, s44
    s_lshr_b32 s75, s74, 1
    s_lshl_b32 s75, s75, 10
    s_and_b32 s74, s74, 1
    s_lshl_b32 s74, s74, 9
    s_add_u32 s74, s74, s75
    s_lshl_b32 s75, s45, 16
    s_add_u32 s20, s74, s75
    v_lshrrev_b32 v254, 1, v3
    v_mfma_f32_16x16x32_bf16 v[108:111], v[136:139], v[172:175], 0
    ds_read_b64 a[192:193], v94 offset:64
    v_lshlrev_b32 v254, 8, v254
    v_lshl_add_u32 v254, v2, 4, v254
    v_mfma_f32_16x16x32_bf16 v[112:115], v[136:139], v[176:179], 0
    ds_read_b64 a[194:195], v94 offset:72
    v_and_b32 v63, 1, v3
    v_lshl_add_u32 v254, v63, 3, v254
    v_mfma_f32_16x16x32_bf16 v[116:119], v[136:139], v[180:183], 0
    ds_read_b128 a[228:231], v95 offset:3136
    v_mfma_f32_16x16x16_bf16 v[200:203], v[76:77], v[66:67], v[38:41]
    v_mfma_f32_16x16x32_bf16 v[120:123], v[136:139], v[184:187], 0
    ds_read_b64 a[196:197], v94 offset:576
    v_mfma_f32_16x16x16_bf16 v[208:211], v[74:75], v[66:67], v[46:49]
    v_mfma_f32_16x16x32_bf16 v[124:127], v[136:139], v[188:191], 0
    ds_read_b64 a[198:199], v94 offset:584
    v_mfma_f32_16x16x16_bf16 v[204:207], v[78:79], v[68:69], v[38:41]
    v_mfma_f32_16x16x32_bf16 v[128:131], v[136:139], v[192:195], 0
    ds_read_b128 a[232:235], v95 offset:2624
    v_mfma_f32_16x16x16_bf16 v[212:215], v[76:77], v[68:69], v[42:45]
    v_mfma_f32_16x16x32_bf16 v[132:135], v[136:139], v[196:199], 0
    ds_read_b64 a[200:201], v94 offset:1088
    v_mfma_f32_16x16x32_bf16 v[108:111], v[140:143], v[168:171], v[108:111]
    ds_read_b64 a[202:203], v94 offset:1096
    v_max_f32 v200, v200, v208
    v_max_f32 v201, v201, v209
    v_mfma_f32_16x16x32_bf16 v[112:115], v[140:143], v[172:175], v[112:115]
    ds_read_b128 a[236:239], v95 offset:2112
    v_max_f32 v202, v202, v210
    v_max_f32 v203, v203, v211
    v_mfma_f32_16x16x32_bf16 v[116:119], v[140:143], v[176:179], v[116:119]
    ds_read_b64 a[204:205], v94 offset:1600
    v_max3_f32 v216, v200, v201, v202
    v_max_f32 v216, v216, v203
    v_mfma_f32_16x16x32_bf16 v[120:123], v[140:143], v[180:183], v[120:123]
    ds_read_b64 a[206:207], v94 offset:1608
    v_max_f32 v204, v204, v212
    v_max_f32 v205, v205, v213
    v_mfma_f32_16x16x32_bf16 v[124:127], v[140:143], v[184:187], v[124:127]
    ds_read_b128 a[240:243], v95 offset:1600
    v_max_f32 v206, v206, v214
    v_max_f32 v207, v207, v215
    v_mfma_f32_16x16x32_bf16 v[128:131], v[140:143], v[188:191], v[128:131]
    ds_read_b64 a[208:209], v94 offset:2112
    v_max3_f32 v217, v204, v205, v206
    v_max_f32 v217, v217, v207
    v_mfma_f32_16x16x32_bf16 v[132:135], v[140:143], v[192:195], v[132:135]
    ds_read_b64 a[210:211], v94 offset:2120
    v_mov_b32 v218, v216
    v_mov_b32 v219, v217
    v_mfma_f32_16x16x32_bf16 v[112:115], v[144:147], v[168:171], v[112:115]
    ds_read_b128 a[244:247], v95 offset:1088
    v_permlane16_swap_b32 v216, v218
    v_permlane16_swap_b32 v217, v219
    v_mfma_f32_16x16x32_bf16 v[116:119], v[144:147], v[172:175], v[116:119]
    ds_read_b64 a[212:213], v94 offset:2624
    v_max_f32 v216, v216, v218
    v_max_f32 v217, v217, v219
    v_mfma_f32_16x16x32_bf16 v[120:123], v[144:147], v[176:179], v[120:123]
    ds_read_b64 a[214:215], v94 offset:2632
    v_mov_b32 v218, v216
    v_mov_b32 v219, v217
    v_mfma_f32_16x16x32_bf16 v[124:127], v[144:147], v[180:183], v[124:127]
    ds_read_b128 a[248:251], v95 offset:576
    v_permlane32_swap_b32 v216, v218
    v_permlane32_swap_b32 v217, v219
    v_mfma_f32_16x16x32_bf16 v[128:131], v[144:147], v[184:187], v[128:131]
    ds_read_b64 a[216:217], v94 offset:3136
    v_max_f32 v216, v216, v218
    v_max_f32 v217, v217, v219
    v_mfma_f32_16x16x32_bf16 v[132:135], v[144:147], v[188:191], v[132:135]
    ds_read_b64 a[218:219], v94 offset:3144
    v_mul_f32 v216, 0x3eb8aa3b, v216
    v_mul_f32 v217, 0x3eb8aa3b, v217
    v_mfma_f32_16x16x32_bf16 v[116:119], v[148:151], v[168:171], v[116:119]
    ds_read_b128 a[252:255], v95 offset:64
    v_fma_f32 v200, v200, s17, -v216
    v_fma_f32 v201, v201, s17, -v216
    v_mfma_f32_16x16x32_bf16 v[120:123], v[148:151], v[172:175], v[120:123]
    ds_read_b64 a[220:221], v94 offset:3648
    v_fma_f32 v202, v202, s17, -v216
    v_fma_f32 v203, v203, s17, -v216
    v_mfma_f32_16x16x32_bf16 v[124:127], v[148:151], v[176:179], v[124:127]
    ds_read_b64 a[222:223], v94 offset:3656
    v_fma_f32 v204, v204, s17, -v217
    v_fma_f32 v205, v205, s17, -v217
    v_mfma_f32_16x16x32_bf16 v[128:131], v[148:151], v[180:183], v[128:131]
    v_fma_f32 v206, v206, s17, -v217
    v_fma_f32 v207, v207, s17, -v217
    v_mfma_f32_16x16x32_bf16 v[132:135], v[148:151], v[184:187], v[132:135]
    v_exp_f32 v200, v200
    v_exp_f32 v201, v201
    v_mfma_f32_16x16x32_bf16 v[120:123], v[152:155], v[168:171], v[120:123]
    v_exp_f32 v202, v202
    v_exp_f32 v203, v203
    v_mfma_f32_16x16x32_bf16 v[124:127], v[152:155], v[172:175], v[124:127]
    v_exp_f32 v204, v204
    v_exp_f32 v205, v205
    v_mfma_f32_16x16x32_bf16 v[128:131], v[152:155], v[176:179], v[128:131]
    v_exp_f32 v206, v206
    v_exp_f32 v207, v207
    v_mfma_f32_16x16x32_bf16 v[132:135], v[152:155], v[180:183], v[132:135]
    v_cvt_pk_bf16_f32 v208, v200, v201
    v_cvt_pk_bf16_f32 v209, v202, v203
    v_mfma_f32_16x16x32_bf16 v[124:127], v[156:159], v[168:171], v[124:127]
    v_and_b32 v220, v52, v208
    v_and_b32 v221, v53, v209
    v_mfma_f32_16x16x32_bf16 v[128:131], v[156:159], v[172:175], v[128:131]
    v_and_b32 v222, v50, v208
    v_and_b32 v223, v51, v209
    v_mfma_f32_16x16x32_bf16 v[132:135], v[156:159], v[176:179], v[132:135]
    v_cvt_pk_bf16_f32 v212, v204, v205
    v_cvt_pk_bf16_f32 v213, v206, v207
    v_mfma_f32_16x16x32_bf16 v[128:131], v[160:163], v[168:171], v[128:131]
    v_and_b32 v224, v52, v212
    v_and_b32 v225, v53, v213
    v_mfma_f32_16x16x32_bf16 v[132:135], v[160:163], v[172:175], v[132:135]
    v_and_b32 v226, v50, v212
    v_and_b32 v227, v51, v213
    v_mfma_f32_16x16x32_bf16 v[132:135], v[164:167], v[168:171], v[132:135]
    v_mfma_f32_16x16x32_bf16 v[246:249], v[54:57], v[220:223], 0
    s_waitcnt lgkmcnt(0)
    v_mfma_f32_16x16x32_bf16 v[104:107], a[192:195], a[224:227], v[104:107]
    ds_read_b128 v[168:171], v95 offset:3712
    v_mfma_f32_16x16x32_bf16 v[238:241], v[84:87], v[220:223], 0
    v_mfma_f32_16x16x32_bf16 v[108:111], a[192:195], a[228:231], v[108:111]
    ds_read_b64 v[136:137], v94 offset:128
    v_mfma_f32_16x16x32_bf16 v[250:253], v[54:57], v[224:227], 0
    v_mfma_f32_16x16x32_bf16 v[112:115], a[192:195], a[232:235], v[112:115]
    ds_read_b64 v[138:139], v94 offset:136
    v_mfma_f32_16x16x32_bf16 v[242:245], v[86:89], v[224:227], 0
    v_mfma_f32_16x16x32_bf16 v[116:119], a[192:195], a[236:239], v[116:119]
    ds_read_b128 v[172:175], v95 offset:3200
    v_mfma_f32_16x16x32_bf16 v[120:123], a[192:195], a[240:243], v[120:123]
    ds_read_b64 v[140:141], v94 offset:640
    v_rcp_f32 v246, v246
    v_rcp_f32 v250, v250
    v_mfma_f32_16x16x32_bf16 v[124:127], a[192:195], a[244:247], v[124:127]
    ds_read_b64 v[142:143], v94 offset:648
    v_mul_f32 v238, v246, v238
    v_mul_f32 v239, v246, v239
    v_mfma_f32_16x16x32_bf16 v[128:131], a[192:195], a[248:251], v[128:131]
    ds_read_b128 v[176:179], v95 offset:2688
    v_mul_f32 v240, v246, v240
    v_mul_f32 v241, v246, v241
    v_mfma_f32_16x16x32_bf16 v[132:135], a[192:195], a[252:255], v[132:135]
    ds_read_b64 v[144:145], v94 offset:1152
    v_cvt_pk_bf16_f32 v238, v238, v239
    v_cvt_pk_bf16_f32 v239, v240, v241
    v_mfma_f32_16x16x32_bf16 v[108:111], a[196:199], a[224:227], v[108:111]
    ds_read_b64 v[146:147], v94 offset:1160
    v_mul_f32 v242, v250, v242
    v_mul_f32 v243, v250, v243
    v_mfma_f32_16x16x32_bf16 v[112:115], a[196:199], a[228:231], v[112:115]
    ds_read_b128 v[180:183], v95 offset:2176
    v_mul_f32 v244, v250, v244
    v_mul_f32 v245, v250, v245
    v_mfma_f32_16x16x32_bf16 v[116:119], a[196:199], a[232:235], v[116:119]
    ds_read_b64 v[148:149], v94 offset:1664
    v_cvt_pk_bf16_f32 v242, v242, v243
    v_cvt_pk_bf16_f32 v243, v244, v245
    v_mfma_f32_16x16x32_bf16 v[120:123], a[196:199], a[236:239], v[120:123]
    ds_read_b64 v[150:151], v94 offset:1672
    s_cmp_eq_u32 s52, 0
    s_cbranch_scc1 L_sg_9
    s_add_u32 s75, s20, 0
    buffer_store_dwordx2 v[238:239], v254, s[12:15], s75 offen
    s_add_u32 s75, s20, 16384
    buffer_store_dwordx2 v[242:243], v254, s[12:15], s75 offen
    s_branch L_sj_10
L_sg_9:
    s_add_u32 s75, s20, 0
    buffer_store_dwordx2 v[238:239], v254, s[12:15], s75 offen sc1
    s_add_u32 s75, s20, 16384
    buffer_store_dwordx2 v[242:243], v254, s[12:15], s75 offen sc1
L_sj_10:
    v_mfma_f32_16x16x32_bf16 v[124:127], a[196:199], a[240:243], v[124:127]
    ds_read_b128 v[184:187], v95 offset:1664
    v_mfma_f32_16x16x16_bf16 v[200:203], v[80:81], v[70:71], v[38:41]
    v_mfma_f32_16x16x32_bf16 v[128:131], a[196:199], a[244:247], v[128:131]
    ds_read_b64 v[152:153], v94 offset:2176
    v_mfma_f32_16x16x16_bf16 v[208:211], v[78:79], v[70:71], v[42:45]
    v_mfma_f32_16x16x32_bf16 v[132:135], a[196:199], a[248:251], v[132:135]
    ds_read_b64 v[154:155], v94 offset:2184
    v_mfma_f32_16x16x16_bf16 v[204:207], v[82:83], v[72:73], v[38:41]
    v_mfma_f32_16x16x32_bf16 v[112:115], a[200:203], a[224:227], v[112:115]
    ds_read_b128 v[188:191], v95 offset:1152
    v_mfma_f32_16x16x16_bf16 v[212:215], v[80:81], v[72:73], v[42:45]
    v_mfma_f32_16x16x32_bf16 v[116:119], a[200:203], a[228:231], v[116:119]
    ds_read_b64 v[156:157], v94 offset:2688
    v_mfma_f32_16x16x32_bf16 v[120:123], a[200:203], a[232:235], v[120:123]
    ds_read_b64 v[158:159], v94 offset:2696
    v_max_f32 v200, v200, v208
    v_max_f32 v201, v201, v209
    v_mfma_f32_16x16x32_bf16 v[124:127], a[200:203], a[236:239], v[124:127]
    ds_read_b128 v[192:195], v95 offset:640
    v_max_f32 v202, v202, v210
    v_max_f32 v203, v203, v211
    v_mfma_f32_16x16x32_bf16 v[128:131], a[200:203], a[240:243], v[128:131]
    ds_read_b64 v[160:161], v94 offset:3200
    v_max3_f32 v216, v200, v201, v202
    v_max_f32 v216, v216, v203
    v_mfma_f32_16x16x32_bf16 v[132:135], a[200:203], a[244:247], v[132:135]
    ds_read_b64 v[162:163], v94 offset:3208
    v_max_f32 v204, v204, v212
    v_max_f32 v205, v205, v213
    v_mfma_f32_16x16x32_bf16 v[116:119], a[204:207], a[224:227], v[116:119]
    ds_read_b128 v[196:199], v95 offset:128
    v_max_f32 v206, v206, v214
    v_max_f32 v207, v207, v215
    v_mfma_f32_16x16x32_bf16 v[120:123], a[204:207], a[228:231], v[120:123]
    ds_read_b64 v[164:165], v94 offset:3712
    v_max3_f32 v217, v204, v205, v206
    v_max_f32 v217, v217, v207
    v_mfma_f32_16x16x32_bf16 v[124:127], a[204:207], a[232:235], v[124:127]
    ds_read_b64 v[166:167], v94 offset:3720
    v_mov_b32 v218, v216
    v_mov_b32 v219, v217
    v_mfma_f32_16x16x32_bf16 v[128:131], a[204:207], a[236:239], v[128:131]
    v_permlane16_swap_b32 v216, v218
    v_permlane16_swap_b32 v217, v219
    v_mfma_f32_16x16x32_bf16 v[132:135], a[204:207], a[240:243], v[132:135]
    v_max_f32 v216, v216, v218
    v_max_f32 v217, v217, v219
    v_mfma_f32_16x16x32_bf16 v[120:123], a[208:211], a[224:227], v[120:123]
    v_mov_b32 v218, v216
    v_mov_b32 v219, v217
    v_mfma_f32_16x16x32_bf16 v[124:127], a[208:211], a[228:231], v[124:127]
    v_permlane32_swap_b32 v216, v218
    v_permlane32_swap_b32 v217, v219
    v_mfma_f32_16x16x32_bf16 v[128:131], a[208:211], a[232:235], v[128:131]
    v_max_f32 v216, v216, v218
    v_max_f32 v217, v217, v219
    v_mfma_f32_16x16x32_bf16 v[132:135], a[208:211], a[236:239], v[132:135]
    v_mul_f32 v216, 0x3eb8aa3b, v216
    v_mul_f32 v217, 0x3eb8aa3b, v217
    v_mfma_f32_16x16x32_bf16 v[124:127], a[212:215], a[224:227], v[124:127]
    v_fma_f32 v200, v200, s17, -v216
    v_fma_f32 v201, v201, s17, -v216
    v_mfma_f32_16x16x32_bf16 v[128:131], a[212:215], a[228:231], v[128:131]
    v_fma_f32 v202, v202, s17, -v216
    v_fma_f32 v203, v203, s17, -v216
    v_mfma_f32_16x16x32_bf16 v[132:135], a[212:215], a[232:235], v[132:135]
    v_fma_f32 v204, v204, s17, -v217
    v_fma_f32 v205, v205, s17, -v217
    v_mfma_f32_16x16x32_bf16 v[128:131], a[216:219], a[224:227], v[128:131]
    v_fma_f32 v206, v206, s17, -v217
    v_fma_f32 v207, v207, s17, -v217
    v_mfma_f32_16x16x32_bf16 v[132:135], a[216:219], a[228:231], v[132:135]
    v_exp_f32 v200, v200
    v_exp_f32 v201, v201
    v_mfma_f32_16x16x32_bf16 v[132:135], a[220:223], a[224:227], v[132:135]
    v_exp_f32 v202, v202
    v_exp_f32 v203, v203
    s_waitcnt lgkmcnt(0)
    v_mfma_f32_16x16x32_bf16 v[104:107], v[136:139], v[168:171], v[104:107]
    ds_read_b128 a[224:227], v95 offset:3776
    v_exp_f32 v204, v204
    v_exp_f32 v205, v205
    v_mfma_f32_16x16x32_bf16 v[108:111], v[136:139], v[172:175], v[108:111]
    ds_read_b64 a[192:193], v94 offset:192
    v_exp_f32 v206, v206
    v_exp_f32 v207, v207
    v_mfma_f32_16x16x32_bf16 v[112:115], v[136:139], v[176:179], v[112:115]
    ds_read_b64 a[194:195], v94 offset:200
    v_cvt_pk_bf16_f32 v208, v200, v201
    v_cvt_pk_bf16_f32 v209, v202, v203
    v_mfma_f32_16x16x32_bf16 v[116:119], v[136:139], v[180:183], v[116:119]
    ds_read_b128 a[228:231], v95 offset:3264
    v_and_b32 v220, v52, v208
    v_and_b32 v221, v53, v209
    v_mfma_f32_16x16x32_bf16 v[120:123], v[136:139], v[184:187], v[120:123]
    ds_read_b64 a[196:197], v94 offset:704
    v_and_b32 v222, v50, v208
    v_and_b32 v223, v51, v209
    v_mfma_f32_16x16x32_bf16 v[124:127], v[136:139], v[188:191], v[124:127]
    ds_read_b64 a[198:199], v94 offset:712
    v_cvt_pk_bf16_f32 v212, v204, v205
    v_cvt_pk_bf16_f32 v213, v206, v207
    v_mfma_f32_16x16x32_bf16 v[128:131], v[136:139], v[192:195], v[128:131]
    ds_read_b128 a[232:235], v95 offset:2752
    v_and_b32 v224, v52, v212
    v_and_b32 v225, v53, v213
    v_mfma_f32_16x16x32_bf16 v[132:135], v[136:139], v[196:199], v[132:135]
    ds_read_b64 a[200:201], v94 offset:1216
    v_and_b32 v226, v50, v212
    v_and_b32 v227, v51, v213
    v_mfma_f32_16x16x32_bf16 v[108:111], v[140:143], v[168:171], v[108:111]
    ds_read_b64 a[202:203], v94 offset:1224
    v_mfma_f32_16x16x32_bf16 v[246:249], v[54:57], v[220:223], 0
    v_mfma_f32_16x16x32_bf16 v[112:115], v[140:143], v[172:175], v[112:115]
    ds_read_b128 a[236:239], v95 offset:2240
    v_mfma_f32_16x16x32_bf16 v[238:241], v[88:91], v[220:223], 0
    v_mfma_f32_16x16x32_bf16 v[116:119], v[140:143], v[176:179], v[116:119]
    ds_read_b64 a[204:205], v94 offset:1728
    v_mfma_f32_16x16x32_bf16 v[250:253], v[54:57], v[224:227], 0
    v_mfma_f32_16x16x32_bf16 v[120:123], v[140:143], v[180:183], v[120:123]
    ds_read_b64 a[206:207], v94 offset:1736
    v_mfma_f32_16x16x32_bf16 v[242:245], v[90:93], v[224:227], 0
    v_mfma_f32_16x16x32_bf16 v[124:127], v[140:143], v[184:187], v[124:127]
    ds_read_b128 a[240:243], v95 offset:1728
    v_mfma_f32_16x16x32_bf16 v[128:131], v[140:143], v[188:191], v[128:131]
    ds_read_b64 a[208:209], v94 offset:2240
    v_rcp_f32 v246, v246
    v_rcp_f32 v250, v250
    v_mfma_f32_16x16x32_bf16 v[132:135], v[140:143], v[192:195], v[132:135]
    ds_read_b64 a[210:211], v94 offset:2248
    v_mul_f32 v238, v246, v238
    v_mul_f32 v239, v246, v239
    v_mfma_f32_16x16x32_bf16 v[112:115], v[144:147], v[168:171], v[112:115]
    ds_read_b128 a[244:247], v95 offset:1216
    v_mul_f32 v240, v246, v240
    v_mul_f32 v241, v246, v241
    v_mfma_f32_16x16x32_bf16 v[116:119], v[144:147], v[172:175], v[116:119]
    ds_read_b64 a[212:213], v94 offset:2752
    v_cvt_pk_bf16_f32 v238, v238, v239
    v_cvt_pk_bf16_f32 v239, v240, v241
    v_mfma_f32_16x16x32_bf16 v[120:123], v[144:147], v[176:179], v[120:123]
    ds_read_b64 a[214:215], v94 offset:2760
    v_mul_f32 v242, v250, v242
    v_mul_f32 v243, v250, v243
    v_mfma_f32_16x16x32_bf16 v[124:127], v[144:147], v[180:183], v[124:127]
    ds_read_b128 a[248:251], v95 offset:704
    v_mul_f32 v244, v250, v244
    v_mul_f32 v245, v250, v245
    v_mfma_f32_16x16x32_bf16 v[128:131], v[144:147], v[184:187], v[128:131]
    ds_read_b64 a[216:217], v94 offset:3264
    v_cvt_pk_bf16_f32 v242, v242, v243
    v_cvt_pk_bf16_f32 v243, v244, v245
    v_mfma_f32_16x16x32_bf16 v[132:135], v[144:147], v[188:191], v[132:135]
    ds_read_b64 a[218:219], v94 offset:3272
    s_cmp_eq_u32 s52, 0
    s_cbranch_scc1 L_sg_11
    s_add_u32 s75, s20, 32768
    buffer_store_dwordx2 v[238:239], v254, s[12:15], s75 offen
    s_add_u32 s75, s20, 49152
    buffer_store_dwordx2 v[242:243], v254, s[12:15], s75 offen
    s_branch L_sj_12
L_sg_11:
    s_add_u32 s75, s20, 32768
    buffer_store_dwordx2 v[238:239], v254, s[12:15], s75 offen sc1
    s_add_u32 s75, s20, 49152
    buffer_store_dwordx2 v[242:243], v254, s[12:15], s75 offen sc1
L_sj_12:
    v_mfma_f32_16x16x32_bf16 v[116:119], v[148:151], v[168:171], v[116:119]
    ds_read_b128 a[252:255], v95 offset:192
    v_mfma_f32_16x16x32_bf16 v[120:123], v[148:151], v[172:175], v[120:123]
    ds_read_b64 a[220:221], v94 offset:3776
    v_mfma_f32_16x16x32_bf16 v[124:127], v[148:151], v[176:179], v[124:127]
    ds_read_b64 a[222:223], v94 offset:3784
    v_mfma_f32_16x16x32_bf16 v[128:131], v[148:151], v[180:183], v[128:131]
    v_mfma_f32_16x16x32_bf16 v[132:135], v[148:151], v[184:187], v[132:135]
    v_mfma_f32_16x16x32_bf16 v[120:123], v[152:155], v[168:171], v[120:123]
    v_mfma_f32_16x16x32_bf16 v[124:127], v[152:155], v[172:175], v[124:127]
    v_mfma_f32_16x16x32_bf16 v[128:131], v[152:155], v[176:179], v[128:131]
    v_mfma_f32_16x16x32_bf16 v[132:135], v[152:155], v[180:183], v[132:135]
    v_mfma_f32_16x16x32_bf16 v[124:127], v[156:159], v[168:171], v[124:127]
    v_mfma_f32_16x16x32_bf16 v[128:131], v[156:159], v[172:175], v[128:131]
    v_mfma_f32_16x16x32_bf16 v[132:135], v[156:159], v[176:179], v[132:135]
    v_mfma_f32_16x16x32_bf16 v[128:131], v[160:163], v[168:171], v[128:131]
    v_mfma_f32_16x16x32_bf16 v[132:135], v[160:163], v[172:175], v[132:135]
    v_mfma_f32_16x16x32_bf16 v[132:135], v[164:167], v[168:171], v[132:135]
    s_waitcnt lgkmcnt(0)
    v_mfma_f32_16x16x32_bf16 v[104:107], a[192:195], a[224:227], v[104:107]
    s_lshl_b32 s77, s44, 12
    s_add_u32 s77, s77, 42496
    v_add_u32 v96, s77, v4
    s_xor_b32 s77, s44, 1
    s_lshl_b32 s77, s77, 12
    s_add_u32 s77, s77, 42496
    v_add_u32 v97, s77, v4
    v_mfma_f32_16x16x32_bf16 v[108:111], a[192:195], a[228:231], v[108:111]
    v_lshlrev_b32 v98, 5, v2
    v_lshl_add_u32 v98, v3, 3, v98
    v_mfma_f32_16x16x32_bf16 v[112:115], a[192:195], a[232:235], v[112:115]
    s_lshl_b32 s77, s59, 11
    s_sub_u32 s77, s58, s77
    s_add_u32 s77, s77, 2552
    v_sub_u32 v98, s77, v98
    s_lshl_b32 s77, s44, 11
    s_add_u32 s77, s77, 58880
    v_lshlrev_b32 v99, 4, v2
    v_mfma_f32_16x16x32_bf16 v[116:119], a[192:195], a[236:239], v[116:119]
    v_lshl_add_u32 v99, v3, 2, v99
    v_add_u32 v99, s77, v99
    v_mfma_f32_16x16x32_bf16 v[120:123], a[192:195], a[240:243], v[120:123]
    v_add_u32 v100, s77, v4
    v_lshrrev_b32 v101, 5, v1
    v_mfma_f32_16x16x32_bf16 v[124:127], a[192:195], a[244:247], v[124:127]
    v_lshlrev_b32 v101, 8, v101
    v_and_b32 v102, 1, v3
    v_mfma_f32_16x16x32_bf16 v[128:131], a[192:195], a[248:251], v[128:131]
    v_lshl_add_u32 v101, v102, 11, v101
    v_lshl_add_u32 v101, v2, 4, v101
    v_mfma_f32_16x16x32_bf16 v[132:135], a[192:195], a[252:255], v[132:135]
    s_lshl_b32 s78, s59, 10
    s_add_u32 s78, s78, s57
    s_add_u32 s78, s78, 8388608
    s_lshl_b32 s77, s54, 16
    s_and_b32 s79, s54, 0xffff0000
    s_cmp_eq_u32 s60, 0
    s_cselect_b32 s77, s77, s79
    ds_read_b64 v[152:153], v98 offset:1536
    ds_read_b64 v[154:155], v98 offset:1024
    v_mfma_f32_16x16x32_bf16 v[108:111], a[196:199], a[224:227], v[108:111]
    ds_read_b64 v[156:157], v98 offset:512
    ds_read_b64 v[158:159], v98 offset:0
    v_mfma_f32_16x16x32_bf16 v[112:115], a[196:199], a[228:231], v[112:115]
    s_waitcnt lgkmcnt(0)
    v_and_b32 v176, 0xffff0000, v153
    v_lshlrev_b32 v177, 16, v153
    v_mfma_f32_16x16x32_bf16 v[116:119], a[196:199], a[232:235], v[116:119]
    v_and_b32 v178, 0xffff0000, v152
    v_lshlrev_b32 v179, 16, v152
    v_mfma_f32_16x16x32_bf16 v[120:123], a[196:199], a[236:239], v[120:123]
    v_and_b32 v180, 0xffff0000, v155
    v_lshlrev_b32 v181, 16, v155
    v_mfma_f32_16x16x32_bf16 v[124:127], a[196:199], a[240:243], v[124:127]
    v_and_b32 v182, 0xffff0000, v154
    v_lshlrev_b32 v183, 16, v154
    v_mfma_f32_16x16x32_bf16 v[128:131], a[196:199], a[244:247], v[128:131]
    v_and_b32 v184, 0xffff0000, v157
    v_lshlrev_b32 v185, 16, v157
    v_mfma_f32_16x16x32_bf16 v[132:135], a[196:199], a[248:251], v[132:135]
    v_and_b32 v186, 0xffff0000, v156
    v_lshlrev_b32 v187, 16, v156
    v_mfma_f32_16x16x32_bf16 v[112:115], a[200:203], a[224:227], v[112:115]
    v_and_b32 v188, 0xffff0000, v159
    v_lshlrev_b32 v189, 16, v159
    v_mfma_f32_16x16x32_bf16 v[116:119], a[200:203], a[228:231], v[116:119]
    v_and_b32 v190, 0xffff0000, v158
    v_lshlrev_b32 v191, 16, v158
    v_mfma_f32_16x16x32_bf16 v[120:123], a[200:203], a[232:235], v[120:123]
    v_mul_f32 v176, s77, v176
    v_mul_f32 v177, s77, v177
    v_mfma_f32_16x16x32_bf16 v[124:127], a[200:203], a[236:239], v[124:127]
    v_mul_f32 v178, s77, v178
    v_mul_f32 v179, s77, v179
    v_mfma_f32_16x16x32_bf16 v[128:131], a[200:203], a[240:243], v[128:131]
    v_mul_f32 v180, s77, v180
    v_mul_f32 v181, s77, v181
    v_mfma_f32_16x16x32_bf16 v[132:135], a[200:203], a[244:247], v[132:135]
    v_mul_f32 v182, s77, v182
    v_mul_f32 v183, s77, v183
    v_mfma_f32_16x16x32_bf16 v[116:119], a[204:207], a[224:227], v[116:119]
    v_mul_f32 v184, s77, v184
    v_mul_f32 v185, s77, v185
    v_mfma_f32_16x16x32_bf16 v[120:123], a[204:207], a[228:231], v[120:123]
    v_mul_f32 v186, s77, v186
    v_mul_f32 v187, s77, v187
    v_mfma_f32_16x16x32_bf16 v[124:127], a[204:207], a[232:235], v[124:127]
    v_mul_f32 v188, s77, v188
    v_mul_f32 v189, s77, v189
    v_mfma_f32_16x16x32_bf16 v[128:131], a[204:207], a[236:239], v[128:131]
    v_mul_f32 v190, s77, v190
    v_mul_f32 v191, s77, v191
    v_mfma_f32_16x16x32_bf16 v[132:135], a[204:207], a[240:243], v[132:135]
    v_mfma_f32_16x16x32_bf16 v[120:123], a[208:211], a[224:227], v[120:123]
    v_mfma_f32_16x16x32_bf16 v[124:127], a[208:211], a[228:231], v[124:127]
    v_mfma_f32_16x16x32_bf16 v[128:131], a[208:211], a[232:235], v[128:131]
    v_mfma_f32_16x16x32_bf16 v[132:135], a[208:211], a[236:239], v[132:135]
    v_mfma_f32_16x16x32_bf16 v[124:127], a[212:215], a[224:227], v[124:127]
    v_mfma_f32_16x16x32_bf16 v[128:131], a[212:215], a[228:231], v[128:131]
    v_mfma_f32_16x16x32_bf16 v[132:135], a[212:215], a[232:235], v[132:135]
    v_mfma_f32_16x16x32_bf16 v[128:131], a[216:219], a[224:227], v[128:131]
    v_mfma_f32_16x16x32_bf16 v[132:135], a[216:219], a[228:231], v[132:135]
    v_mfma_f32_16x16x32_bf16 v[132:135], a[220:223], a[224:227], v[132:135]
    s_waitcnt vmcnt(0)
    s_add_u32 s74, s18, 11433984
    s_mov_b64 exec, 1
    s_cmp_eq_u32 s52, 0
    s_cbranch_scc1 L_sg_13
    buffer_store_dwordx2 v[36:37], v9, s[12:15], s74 offen
    s_branch L_sj_14
L_sg_13:
    buffer_store_dwordx2 v[36:37], v9, s[12:15], s74 offen sc1
L_sj_14:
    s_mov_b64 exec, -1
    s_nop 1
    s_cmp_eq_u32 s59, 0
    s_cbranch_scc0 L_cvh_15
    ds_write_b128 v96, v[120:123] offset:0
    ds_write_b128 v96, v[124:127] offset:1024
    ds_write_b128 v96, v[128:131] offset:2048
    ds_write_b128 v96, v[132:135] offset:3072
    v_pk_add_f32 v[136:137], v[104:105], v[176:177]
    v_pk_add_f32 v[138:139], v[106:107], v[178:179]
    v_pk_add_f32 v[140:141], v[108:109], v[180:181]
    v_pk_add_f32 v[142:143], v[110:111], v[182:183]
    v_pk_add_f32 v[144:145], v[112:113], v[184:185]
    v_pk_add_f32 v[146:147], v[114:115], v[186:187]
    v_pk_add_f32 v[148:149], v[116:117], v[188:189]
    v_pk_add_f32 v[150:151], v[118:119], v[190:191]
    s_branch L_cvj_16
L_cvh_15:
    ds_write_b128 v96, v[104:107] offset:0
    ds_write_b128 v96, v[108:111] offset:1024
    ds_write_b128 v96, v[112:115] offset:2048
    ds_write_b128 v96, v[116:119] offset:3072
    v_pk_add_f32 v[136:137], v[120:121], v[176:177]
    v_pk_add_f32 v[138:139], v[122:123], v[178:179]
    v_pk_add_f32 v[140:141], v[124:125], v[180:181]
    v_pk_add_f32 v[142:143], v[126:127], v[182:183]
    v_pk_add_f32 v[144:145], v[128:129], v[184:185]
    v_pk_add_f32 v[146:147], v[130:131], v[186:187]
    v_pk_add_f32 v[148:149], v[132:133], v[188:189]
    v_pk_add_f32 v[150:151], v[134:135], v[190:191]
L_cvj_16:
    s_waitcnt lgkmcnt(0)
    s_barrier
    ds_read_b128 v[160:163], v97 offset:0
    ds_read_b128 v[164:167], v97 offset:1024
    ds_read_b128 v[168:171], v97 offset:2048
    ds_read_b128 v[172:175], v97 offset:3072
    s_lshl_b32 s82, s45, 8
    s_add_u32 s82, s82, 11433984
    buffer_load_dwordx2 v[232:233], v236, s[12:15], s82 offen sc1
    s_waitcnt lgkmcnt(3)
    v_pk_add_f32 v[136:137], v[136:137], v[160:161]
    v_pk_add_f32 v[138:139], v[138:139], v[162:163]
    v_cvt_pk_bf16_f32 v176, v136, v138
    ds_write_b32 v99, v176 offset:0
    v_cvt_pk_bf16_f32 v177, v137, v139
    ds_write_b32 v99, v177 offset:256
    s_waitcnt lgkmcnt(4)
    v_pk_add_f32 v[140:141], v[140:141], v[164:165]
    v_pk_add_f32 v[142:143], v[142:143], v[166:167]
    v_cvt_pk_bf16_f32 v178, v140, v142
    ds_write_b32 v99, v178 offset:512
    v_cvt_pk_bf16_f32 v179, v141, v143
    ds_write_b32 v99, v179 offset:768
    s_waitcnt lgkmcnt(5)
    v_pk_add_f32 v[144:145], v[144:145], v[168:169]
    v_pk_add_f32 v[146:147], v[146:147], v[170:171]
    v_cvt_pk_bf16_f32 v180, v144, v146
    ds_write_b32 v99, v180 offset:1024
    v_cvt_pk_bf16_f32 v181, v145, v147
    ds_write_b32 v99, v181 offset:1280
    s_waitcnt lgkmcnt(6)
    v_pk_add_f32 v[148:149], v[148:149], v[172:173]
    v_pk_add_f32 v[150:151], v[150:151], v[174:175]
    v_cvt_pk_bf16_f32 v182, v148, v150
    ds_write_b32 v99, v182 offset:1536
    v_cvt_pk_bf16_f32 v183, v149, v151
    ds_write_b32 v99, v183 offset:1792
    s_waitcnt lgkmcnt(0)
    ds_read_b128 v[228:231], v100
    ds_read_b128 v[238:241], v100 offset:1024
    s_waitcnt lgkmcnt(0)
    buffer_store_dwordx4 v[228:231], v101, s[12:15], s78 offen sc1
    buffer_store_dwordx4 v[238:241], v101, s[12:15], s78 offen offset:512 sc1
    s_lshl_b32 s74, s46, 7
    s_add_u32 s56, s56, s74
    s_lshl_b32 s84, s45, 16
    s_lshl_b32 s85, s44, 14
    s_add_u32 s84, s84, s85
    s_cmp_eq_u32 s52, 0
    s_cselect_b32 s85, 0, 0
    s_add_u32 s84, s84, s85
    s_lshl_b32 s81, s46, 8
    s_add_u32 s81, s81, 11425792
    s_lshl_b32 s83, s46, 18
    s_lshl_b32 s75, s47, 11
    s_add_u32 s83, s83, s75
    s_lshl_b32 s75, s48, 7
    s_add_u32 s83, s83, s75
    s_lshl_b32 s75, s44, 16
    s_add_u32 s83, s83, s75
    s_add_u32 s83, s83, 8388608
    s_add_u32 s22, s83, 32768
    v_lshrrev_b32 v75, 3, v1
    v_lshlrev_b32 v75, 12, v75
    v_and_b32 v76, 0x70, v4
    v_add_u32 v75, v75, v76
    s_lshl_b32 s23, s44, 11
    s_add_u32 s23, s23, 147456
    v_bfe_u32 v79, v1, 2, 2
    v_lshl_add_u32 v79, v3, 2, v79
    v_lshlrev_b32 v79, 7, v79
    v_and_b32 v76, 3, v1
    v_lshl_add_u32 v79, v76, 3, v79
    s_lshl_b32 s75, s44, 5
    s_add_u32 s75, s75, 147456
    v_add_u32 v79, s75, v79
    s_waitcnt vmcnt(2)
    s_mov_b32 s61, 0
L_po1_17:
    v_xor_b32 v68, s50, v232
    v_xor_b32 v69, s51, v233
    v_or_b32 v68, v68, v69
    v_cmp_ne_u32 vcc, 0, v68
    s_add_u32 s61, s61, 1
    s_cmp_gt_u32 s61, 40000
    s_cbranch_scc1 L_po1d_18
    s_nop 1
    s_cbranch_vccz L_po1d_18
    s_sleep 1
    buffer_load_dwordx2 v[232:233], v236, s[12:15], s82 offen sc1
    s_waitcnt vmcnt(0)
    s_branch L_po1_17
L_po1d_18:
    s_add_u32 s85, s84, 0
    buffer_load_dwordx4 a[192:195], v4, s[12:15], s85 offen offset:0 sc1
    buffer_load_dwordx4 a[196:199], v4, s[12:15], s85 offen offset:1024 sc1
    buffer_load_dwordx4 a[200:203], v4, s[12:15], s85 offen offset:2048 sc1
    buffer_load_dwordx4 a[204:207], v4, s[12:15], s85 offen offset:3072 sc1
    s_add_u32 s85, s84, 4096
    buffer_load_dwordx4 a[208:211], v4, s[12:15], s85 offen offset:0 sc1
    buffer_load_dwordx4 a[212:215], v4, s[12:15], s85 offen offset:1024 sc1
    s_lshl_b32 s75, s44, 15
    s_add_u32 s79, s56, s75
    buffer_load_dwordx2 v[96:97], v8, s[4:7], s79 offen offset:0
    buffer_load_dwordx2 v[98:99], v8, s[4:7], s79 offen offset:32
    buffer_load_dwordx2 v[100:101], v8, s[4:7], s79 offen offset:64
    buffer_load_dwordx2 v[102:103], v8, s[4:7], s79 offen offset:96
    ds_read_b64_tr_b16 v[112:113], v58 offset:0
    ds_read_b64_tr_b16 v[114:115], v58 offset:512
    ds_read_b64_tr_b16 v[116:117], v59 offset:0
    ds_read_b64_tr_b16 v[118:119], v59 offset:512
    ds_read_b64_tr_b16 v[120:121], v60 offset:0
    ds_read_b64_tr_b16 v[122:123], v60 offset:512
    ds_read_b64_tr_b16 v[124:125], v61 offset:0
    ds_read_b64_tr_b16 v[126:127], v61 offset:512
    ds_read_b64_tr_b16 v[144:145], v58 offset:4096
    ds_read_b64_tr_b16 v[146:147], v58 offset:4608
    ds_read_b64_tr_b16 v[148:149], v59 offset:4096
    ds_read_b64_tr_b16 v[150:151], v59 offset:4608
    ds_read_b64_tr_b16 v[152:153], v60 offset:4096
    ds_read_b64_tr_b16 v[154:155], v60 offset:4608
    ds_read_b64_tr_b16 v[156:157], v61 offset:4096
    ds_read_b64_tr_b16 v[158:159], v61 offset:4608
    s_waitcnt vmcnt(10)
    s_barrier
    s_cmp_lg_u32 s44, 0
    s_cbranch_scc1 L_nfy_19
    s_lshl_b32 s74, s2, 3
    s_add_u32 s74, s74, 11425792
    s_mov_b64 exec, 1
    buffer_store_dwordx2 v[36:37], v9, s[12:15], s74 offen sc1
    s_mov_b64 exec, -1
L_nfy_19:
    s_waitcnt vmcnt(9) lgkmcnt(8)
    v_mfma_f32_16x16x32_bf16 v[80:83], v[112:115], a[192:195], 0
    buffer_load_dwordx4 a[216:219], v4, s[12:15], s85 offen offset:2048 sc1
    v_mfma_f32_16x16x32_bf16 v[84:87], v[116:119], a[192:195], 0
    ds_read_b64_tr_b16 v[176:177], v58 offset:8192
    ds_read_b64_tr_b16 v[178:179], v58 offset:8704
    ds_read_b64_tr_b16 v[180:181], v59 offset:8192
    ds_read_b64_tr_b16 v[182:183], v59 offset:8704
    v_mfma_f32_16x16x32_bf16 v[88:91], v[120:123], a[192:195], 0
    ds_read_b64_tr_b16 v[184:185], v60 offset:8192
    ds_read_b64_tr_b16 v[186:187], v60 offset:8704
    ds_read_b64_tr_b16 v[188:189], v61 offset:8192
    ds_read_b64_tr_b16 v[190:191], v61 offset:8704
    v_mfma_f32_16x16x32_bf16 v[92:95], v[124:127], a[192:195], 0
    s_waitcnt vmcnt(9) lgkmcnt(8)
    v_mfma_f32_16x16x32_bf16 v[80:83], v[144:147], a[196:199], v[80:83]
    buffer_load_dwordx4 a[220:223], v4, s[12:15], s85 offen offset:3072 sc1
    v_mfma_f32_16x16x32_bf16 v[84:87], v[148:151], a[196:199], v[84:87]
    ds_read_b64_tr_b16 v[112:113], v58 offset:12288
    ds_read_b64_tr_b16 v[114:115], v58 offset:12800
    ds_read_b64_tr_b16 v[116:117], v59 offset:12288
    ds_read_b64_tr_b16 v[118:119], v59 offset:12800
    v_mfma_f32_16x16x32_bf16 v[88:91], v[152:155], a[196:199], v[88:91]
    ds_read_b64_tr_b16 v[120:121], v60 offset:12288
    ds_read_b64_tr_b16 v[122:123], v60 offset:12800
    ds_read_b64_tr_b16 v[124:125], v61 offset:12288
    ds_read_b64_tr_b16 v[126:127], v61 offset:12800
    v_mfma_f32_16x16x32_bf16 v[92:95], v[156:159], a[196:199], v[92:95]
    s_waitcnt vmcnt(9) lgkmcnt(8)
    v_mfma_f32_16x16x32_bf16 v[80:83], v[176:179], a[200:203], v[80:83]
    s_add_u32 s85, s84, 8192
    buffer_load_dwordx4 a[224:227], v4, s[12:15], s85 offen offset:0 sc1
    v_mfma_f32_16x16x32_bf16 v[84:87], v[180:183], a[200:203], v[84:87]
    ds_read_b64_tr_b16 v[144:145], v58 offset:16384
    ds_read_b64_tr_b16 v[146:147], v58 offset:16896
    ds_read_b64_tr_b16 v[148:149], v59 offset:16384
    ds_read_b64_tr_b16 v[150:151], v59 offset:16896
    v_mfma_f32_16x16x32_bf16 v[88:91], v[184:187], a[200:203], v[88:91]
    ds_read_b64_tr_b16 v[152:153], v60 offset:16384
    ds_read_b64_tr_b16 v[154:155], v60 offset:16896
    ds_read_b64_tr_b16 v[156:157], v61 offset:16384
    ds_read_b64_tr_b16 v[158:159], v61 offset:16896
    v_mfma_f32_16x16x32_bf16 v[92:95], v[188:191], a[200:203], v[92:95]
    s_waitcnt vmcnt(9) lgkmcnt(8)
    v_mfma_f32_16x16x32_bf16 v[80:83], v[112:115], a[204:207], v[80:83]
    buffer_load_dwordx4 a[228:231], v4, s[12:15], s85 offen offset:1024 sc1
    v_mfma_f32_16x16x32_bf16 v[84:87], v[116:119], a[204:207], v[84:87]
    ds_read_b64_tr_b16 v[176:177], v58 offset:20480
    ds_read_b64_tr_b16 v[178:179], v58 offset:20992
    ds_read_b64_tr_b16 v[180:181], v59 offset:20480
    ds_read_b64_tr_b16 v[182:183], v59 offset:20992
    v_mfma_f32_16x16x32_bf16 v[88:91], v[120:123], a[204:207], v[88:91]
    ds_read_b64_tr_b16 v[184:185], v60 offset:20480
    ds_read_b64_tr_b16 v[186:187], v60 offset:20992
    ds_read_b64_tr_b16 v[188:189], v61 offset:20480
    ds_read_b64_tr_b16 v[190:191], v61 offset:20992
    v_mfma_f32_16x16x32_bf16 v[92:95], v[124:127], a[204:207], v[92:95]
    s_waitcnt vmcnt(9) lgkmcnt(8)
    v_mfma_f32_16x16x32_bf16 v[80:83], v[144:147], a[208:211], v[80:83]
    buffer_load_dwordx4 a[232:235], v4, s[12:15], s85 offen offset:2048 sc1
    v_mfma_f32_16x16x32_bf16 v[84:87], v[148:151], a[208:211], v[84:87]
    ds_read_b64_tr_b16 v[112:113], v58 offset:24576
    ds_read_b64_tr_b16 v[114:115], v58 offset:25088
    ds_read_b64_tr_b16 v[116:117], v59 offset:24576
    ds_read_b64_tr_b16 v[118:119], v59 offset:25088
    v_mfma_f32_16x16x32_bf16 v[88:91], v[152:155], a[208:211], v[88:91]
    ds_read_b64_tr_b16 v[120:121], v60 offset:24576
    ds_read_b64_tr_b16 v[122:123], v60 offset:25088
    ds_read_b64_tr_b16 v[124:125], v61 offset:24576
    ds_read_b64_tr_b16 v[126:127], v61 offset:25088
    v_mfma_f32_16x16x32_bf16 v[92:95], v[156:159], a[208:211], v[92:95]
    s_waitcnt vmcnt(9) lgkmcnt(8)
    v_mfma_f32_16x16x32_bf16 v[80:83], v[176:179], a[212:215], v[80:83]
    buffer_load_dwordx4 a[236:239], v4, s[12:15], s85 offen offset:3072 sc1
    v_mfma_f32_16x16x32_bf16 v[84:87], v[180:183], a[212:215], v[84:87]
    ds_read_b64_tr_b16 v[144:145], v58 offset:28672
    ds_read_b64_tr_b16 v[146:147], v58 offset:29184
    ds_read_b64_tr_b16 v[148:149], v59 offset:28672
    ds_read_b64_tr_b16 v[150:151], v59 offset:29184
    v_mfma_f32_16x16x32_bf16 v[88:91], v[184:187], a[212:215], v[88:91]
    ds_read_b64_tr_b16 v[152:153], v60 offset:28672
    ds_read_b64_tr_b16 v[154:155], v60 offset:29184
    ds_read_b64_tr_b16 v[156:157], v61 offset:28672
    ds_read_b64_tr_b16 v[158:159], v61 offset:29184
    v_mfma_f32_16x16x32_bf16 v[92:95], v[188:191], a[212:215], v[92:95]
    s_waitcnt vmcnt(5) lgkmcnt(8)
    v_mfma_f32_16x16x32_bf16 v[80:83], v[112:115], a[216:219], v[80:83]
    s_add_u32 s85, s84, 12288
    buffer_load_dwordx4 a[240:243], v4, s[12:15], s85 offen offset:0 sc1
    v_mfma_f32_16x16x32_bf16 v[84:87], v[116:119], a[216:219], v[84:87]
    ds_read_b64_tr_b16 v[176:177], v58 offset:32768
    ds_read_b64_tr_b16 v[178:179], v58 offset:33280
    ds_read_b64_tr_b16 v[180:181], v59 offset:32768
    ds_read_b64_tr_b16 v[182:183], v59 offset:33280
    v_mfma_f32_16x16x32_bf16 v[88:91], v[120:123], a[216:219], v[88:91]
    ds_read_b64_tr_b16 v[184:185], v60 offset:32768
    ds_read_b64_tr_b16 v[186:187], v60 offset:33280
    ds_read_b64_tr_b16 v[188:189], v61 offset:32768
    ds_read_b64_tr_b16 v[190:191], v61 offset:33280
    v_mfma_f32_16x16x32_bf16 v[92:95], v[124:127], a[216:219], v[92:95]
    s_waitcnt vmcnt(5) lgkmcnt(8)
    v_mfma_f32_16x16x32_bf16 v[80:83], v[144:147], a[220:223], v[80:83]
    buffer_load_dwordx4 a[244:247], v4, s[12:15], s85 offen offset:1024 sc1
    v_mfma_f32_16x16x32_bf16 v[84:87], v[148:151], a[220:223], v[84:87]
    ds_read_b64_tr_b16 v[112:113], v58 offset:36864
    ds_read_b64_tr_b16 v[114:115], v58 offset:37376
    ds_read_b64_tr_b16 v[116:117], v59 offset:36864
    ds_read_b64_tr_b16 v[118:119], v59 offset:37376
    v_mfma_f32_16x16x32_bf16 v[88:91], v[152:155], a[220:223], v[88:91]
    ds_read_b64_tr_b16 v[120:121], v60 offset:36864
    ds_read_b64_tr_b16 v[122:123], v60 offset:37376
    ds_read_b64_tr_b16 v[124:125], v61 offset:36864
    ds_read_b64_tr_b16 v[126:127], v61 offset:37376
    v_mfma_f32_16x16x32_bf16 v[92:95], v[156:159], a[220:223], v[92:95]
    s_waitcnt vmcnt(5) lgkmcnt(8)
    v_mfma_f32_16x16x32_bf16 v[80:83], v[176:179], a[224:227], v[80:83]
    buffer_load_dwordx4 a[248:251], v4, s[12:15], s85 offen offset:2048 sc1
    v_mfma_f32_16x16x32_bf16 v[84:87], v[180:183], a[224:227], v[84:87]
    ds_read_b64_tr_b16 v[144:145], v58 offset:40960
    ds_read_b64_tr_b16 v[146:147], v58 offset:41472
    ds_read_b64_tr_b16 v[148:149], v59 offset:40960
    ds_read_b64_tr_b16 v[150:151], v59 offset:41472
    v_mfma_f32_16x16x32_bf16 v[88:91], v[184:187], a[224:227], v[88:91]
    ds_read_b64_tr_b16 v[152:153], v60 offset:40960
    ds_read_b64_tr_b16 v[154:155], v60 offset:41472
    ds_read_b64_tr_b16 v[156:157], v61 offset:40960
    ds_read_b64_tr_b16 v[158:159], v61 offset:41472
    v_mfma_f32_16x16x32_bf16 v[92:95], v[188:191], a[224:227], v[92:95]
    s_waitcnt vmcnt(5) lgkmcnt(8)
    v_mfma_f32_16x16x32_bf16 v[80:83], v[112:115], a[228:231], v[80:83]
    buffer_load_dwordx4 a[252:255], v4, s[12:15], s85 offen offset:3072 sc1
    v_mfma_f32_16x16x32_bf16 v[84:87], v[116:119], a[228:231], v[84:87]
    ds_read_b64_tr_b16 v[176:177], v58 offset:45056
    ds_read_b64_tr_b16 v[178:179], v58 offset:45568
    ds_read_b64_tr_b16 v[180:181], v59 offset:45056
    ds_read_b64_tr_b16 v[182:183], v59 offset:45568
    v_mfma_f32_16x16x32_bf16 v[88:91], v[120:123], a[228:231], v[88:91]
    ds_read_b64_tr_b16 v[184:185], v60 offset:45056
    ds_read_b64_tr_b16 v[186:187], v60 offset:45568
    ds_read_b64_tr_b16 v[188:189], v61 offset:45056
    ds_read_b64_tr_b16 v[190:191], v61 offset:45568
    v_mfma_f32_16x16x32_bf16 v[92:95], v[124:127], a[228:231], v[92:95]
    s_waitcnt vmcnt(5) lgkmcnt(8)
    v_mfma_f32_16x16x32_bf16 v[80:83], v[144:147], a[232:235], v[80:83]
    ds_read_b64_tr_b16 v[112:113], v58 offset:49152
    ds_read_b64_tr_b16 v[114:115], v58 offset:49664
    ds_read_b64_tr_b16 v[116:117], v59 offset:49152
    ds_read_b64_tr_b16 v[118:119], v59 offset:49664
    v_mfma_f32_16x16x32_bf16 v[84:87], v[148:151], a[232:235], v[84:87]
    ds_read_b64_tr_b16 v[120:121], v60 offset:49152
    ds_read_b64_tr_b16 v[122:123], v60 offset:49664
    ds_read_b64_tr_b16 v[124:125], v61 offset:49152
    ds_read_b64_tr_b16 v[126:127], v61 offset:49664
    v_mfma_f32_16x16x32_bf16 v[88:91], v[152:155], a[232:235], v[88:91]
    v_mfma_f32_16x16x32_bf16 v[92:95], v[156:159], a[232:235], v[92:95]
    s_waitcnt vmcnt(4) lgkmcnt(8)
    v_mfma_f32_16x16x32_bf16 v[80:83], v[176:179], a[236:239], v[80:83]
    ds_read_b64_tr_b16 v[144:145], v58 offset:53248
    ds_read_b64_tr_b16 v[146:147], v58 offset:53760
    ds_read_b64_tr_b16 v[148:149], v59 offset:53248
    ds_read_b64_tr_b16 v[150:151], v59 offset:53760
    v_mfma_f32_16x16x32_bf16 v[84:87], v[180:183], a[236:239], v[84:87]
    ds_read_b64_tr_b16 v[152:153], v60 offset:53248
    ds_read_b64_tr_b16 v[154:155], v60 offset:53760
    ds_read_b64_tr_b16 v[156:157], v61 offset:53248
    ds_read_b64_tr_b16 v[158:159], v61 offset:53760
    v_mfma_f32_16x16x32_bf16 v[88:91], v[184:187], a[236:239], v[88:91]
    v_mfma_f32_16x16x32_bf16 v[92:95], v[188:191], a[236:239], v[92:95]
    s_waitcnt vmcnt(3) lgkmcnt(8)
    v_mfma_f32_16x16x32_bf16 v[80:83], v[112:115], a[240:243], v[80:83]
    ds_read_b64_tr_b16 v[176:177], v58 offset:57344
    ds_read_b64_tr_b16 v[178:179], v58 offset:57856
    ds_read_b64_tr_b16 v[180:181], v59 offset:57344
    ds_read_b64_tr_b16 v[182:183], v59 offset:57856
    v_mfma_f32_16x16x32_bf16 v[84:87], v[116:119], a[240:243], v[84:87]
    ds_read_b64_tr_b16 v[184:185], v60 offset:57344
    ds_read_b64_tr_b16 v[186:187], v60 offset:57856
    ds_read_b64_tr_b16 v[188:189], v61 offset:57344
    ds_read_b64_tr_b16 v[190:191], v61 offset:57856
    v_mfma_f32_16x16x32_bf16 v[88:91], v[120:123], a[240:243], v[88:91]
    v_mfma_f32_16x16x32_bf16 v[92:95], v[124:127], a[240:243], v[92:95]
    s_waitcnt vmcnt(2) lgkmcnt(8)
    v_mfma_f32_16x16x32_bf16 v[80:83], v[144:147], a[244:247], v[80:83]
    ds_read_b64_tr_b16 v[112:113], v58 offset:61440
    ds_read_b64_tr_b16 v[114:115], v58 offset:61952
    ds_read_b64_tr_b16 v[116:117], v59 offset:61440
    ds_read_b64_tr_b16 v[118:119], v59 offset:61952
    v_mfma_f32_16x16x32_bf16 v[84:87], v[148:151], a[244:247], v[84:87]
    ds_read_b64_tr_b16 v[120:121], v60 offset:61440
    ds_read_b64_tr_b16 v[122:123], v60 offset:61952
    ds_read_b64_tr_b16 v[124:125], v61 offset:61440
    ds_read_b64_tr_b16 v[126:127], v61 offset:61952
    v_mfma_f32_16x16x32_bf16 v[88:91], v[152:155], a[244:247], v[88:91]
    v_mfma_f32_16x16x32_bf16 v[92:95], v[156:159], a[244:247], v[92:95]
    s_waitcnt vmcnt(1) lgkmcnt(8)
    v_mfma_f32_16x16x32_bf16 v[80:83], v[176:179], a[248:251], v[80:83]
    v_mfma_f32_16x16x32_bf16 v[84:87], v[180:183], a[248:251], v[84:87]
    v_mfma_f32_16x16x32_bf16 v[88:91], v[184:187], a[248:251], v[88:91]
    v_mfma_f32_16x16x32_bf16 v[92:95], v[188:191], a[248:251], v[92:95]
    s_waitcnt vmcnt(0) lgkmcnt(0)
    v_mfma_f32_16x16x32_bf16 v[80:83], v[112:115], a[252:255], v[80:83]
    v_mfma_f32_16x16x32_bf16 v[84:87], v[116:119], a[252:255], v[84:87]
    v_mfma_f32_16x16x32_bf16 v[88:91], v[120:123], a[252:255], v[88:91]
    v_mfma_f32_16x16x32_bf16 v[92:95], v[124:127], a[252:255], v[92:95]
    v_lshlrev_b32 v144, 16, v96
    v_and_b32 v145, 0xffff0000, v96
    v_lshlrev_b32 v146, 16, v97
    v_and_b32 v147, 0xffff0000, v97
    v_lshlrev_b32 v148, 16, v98
    v_and_b32 v149, 0xffff0000, v98
    v_lshlrev_b32 v150, 16, v99
    v_and_b32 v151, 0xffff0000, v99
    v_lshlrev_b32 v152, 16, v100
    v_and_b32 v153, 0xffff0000, v100
    v_lshlrev_b32 v154, 16, v101
    v_and_b32 v155, 0xffff0000, v101
    v_lshlrev_b32 v156, 16, v102
    v_and_b32 v157, 0xffff0000, v102
    v_lshlrev_b32 v158, 16, v103
    v_and_b32 v159, 0xffff0000, v103
    v_mov_b32 v168, 0
    v_mov_b32 v169, 0
    v_mov_b32 v170, s50
    v_mov_b32 v171, s51
    v_pk_add_f32 v[144:145], v[144:145], v[80:81]
    v_cvt_pk_bf16_f32 v160, v144, v145
    v_pk_add_f32 v[146:147], v[146:147], v[82:83]
    v_cvt_pk_bf16_f32 v161, v146, v147
    v_pk_add_f32 v[148:149], v[148:149], v[84:85]
    v_cvt_pk_bf16_f32 v162, v148, v149
    v_pk_add_f32 v[150:151], v[150:151], v[86:87]
    v_cvt_pk_bf16_f32 v163, v150, v151
    v_pk_add_f32 v[152:153], v[152:153], v[88:89]
    v_cvt_pk_bf16_f32 v164, v152, v153
    v_pk_add_f32 v[154:155], v[154:155], v[90:91]
    v_cvt_pk_bf16_f32 v165, v154, v155
    v_pk_add_f32 v[156:157], v[156:157], v[92:93]
    v_cvt_pk_bf16_f32 v166, v156, v157
    v_pk_add_f32 v[158:159], v[158:159], v[94:95]
    v_cvt_pk_bf16_f32 v167, v158, v159
    v_dot2_f32_bf16 v168, v160, v54, v168
    v_dot2_f32_bf16 v169, v160, v160, v169
    v_dot2_f32_bf16 v168, v161, v54, v168
    v_dot2_f32_bf16 v169, v161, v161, v169
    v_dot2_f32_bf16 v168, v162, v54, v168
    v_dot2_f32_bf16 v169, v162, v162, v169
    v_dot2_f32_bf16 v168, v163, v54, v168
    v_dot2_f32_bf16 v169, v163, v163, v169
    v_dot2_f32_bf16 v168, v164, v54, v168
    v_dot2_f32_bf16 v169, v164, v164, v169
    v_dot2_f32_bf16 v168, v165, v54, v168
    v_dot2_f32_bf16 v169, v165, v165, v169
    v_dot2_f32_bf16 v168, v166, v54, v168
    v_dot2_f32_bf16 v169, v166, v166, v169
    v_dot2_f32_bf16 v168, v167, v54, v168
    v_dot2_f32_bf16 v169, v167, v167, v169
    s_lshl_b32 s80, s45, 13
    s_lshl_b32 s75, s44, 11
    s_add_u32 s80, s80, s75
    s_add_u32 s80, s80, 10485760
    s_lshl_b32 s75, s46, 8
    s_add_u32 s75, s75, s80
    v_mov_b32 v172, v168
    v_mov_b32 v173, v169
    s_nop 0
    v_permlane16_swap_b32 v168, v172
    v_permlane16_swap_b32 v169, v173
    s_nop 0
    v_add_f32 v168, v168, v172
    v_add_f32 v169, v169, v173
    v_mov_b32 v172, v168
    v_mov_b32 v173, v169
    s_nop 0
    v_permlane32_swap_b32 v168, v172
    v_permlane32_swap_b32 v169, v173
    s_nop 0
    v_add_f32 v168, v168, v172
    v_add_f32 v169, v169, v173
    s_mov_b64 exec, 0xffff
    s_cmp_eq_u32 s52, 0
    s_cbranch_scc1 L_sg_20
    buffer_store_dwordx4 v[168:171], v4, s[12:15], s75 offen
    s_branch L_sj_21
L_sg_20:
    buffer_store_dwordx4 v[168:171], v4, s[12:15], s75 offen sc1
L_sj_21:
    s_mov_b64 exec, -1
    v_lshlrev_b32 v144, 16, v160
    v_and_b32 v145, 0xffff0000, v160
    v_lshlrev_b32 v146, 16, v161
    v_and_b32 v147, 0xffff0000, v161
    v_lshlrev_b32 v148, 16, v162
    v_and_b32 v149, 0xffff0000, v162
    v_lshlrev_b32 v150, 16, v163
    v_and_b32 v151, 0xffff0000, v163
    v_lshlrev_b32 v152, 16, v164
    v_and_b32 v153, 0xffff0000, v164
    v_lshlrev_b32 v154, 16, v165
    v_and_b32 v155, 0xffff0000, v165
    v_lshlrev_b32 v156, 16, v166
    v_and_b32 v157, 0xffff0000, v166
    v_lshlrev_b32 v158, 16, v167
    v_and_b32 v159, 0xffff0000, v167
    s_cmp_lg_u32 s44, 0
    s_cbranch_scc1 L_yd_22
    buffer_load_dwordx2 v[72:73], v236, s[12:15], s81 offen sc1
    s_waitcnt vmcnt(0)
    s_mov_b32 s61, 0
L_pfy_23:
    v_xor_b32 v76, s50, v72
    v_xor_b32 v77, s51, v73
    v_or_b32 v76, v76, v77
    v_cmp_ne_u32 vcc, 0, v76
    s_add_u32 s61, s61, 1
    s_cmp_gt_u32 s61, 40000
    s_cbranch_scc1 L_pfyd_24
    s_nop 1
    s_cbranch_vccz L_pfyd_24
    s_sleep 3
    buffer_load_dwordx2 v[72:73], v236, s[12:15], s81 offen sc1
    s_waitcnt vmcnt(0)
    s_branch L_pfy_23
L_pfyd_24:
L_yd_22:
    s_barrier
    s_mov_b32 m0, s23
    s_nop 0
    buffer_load_dwordx4 v75, s[12:15], s83 offen sc1 lds
    s_add_u32 m0, s23, 1024
    s_nop 0
    buffer_load_dwordx4 v75, s[12:15], s22 offen sc1 lds
    buffer_load_dwordx4 v[176:179], v4, s[12:15], s80 offen sc1
    buffer_load_dwordx4 v[180:183], v4, s[12:15], s80 offen offset:1024 sc1
    s_waitcnt vmcnt(2)
    s_barrier
    ds_read_b64_tr_b16 v[246:247], v79 offset:0
    ds_read_b64_tr_b16 v[248:249], v79 offset:2048
    ds_read_b64_tr_b16 v[250:251], v79 offset:4096
    ds_read_b64_tr_b16 v[252:253], v79 offset:6144
    s_waitcnt vmcnt(0)
    s_mov_b32 s61, 0
L_pst_25:
    v_xor_b32 v76, s50, v178
    v_xor_b32 v77, s51, v179
    v_or_b32 v76, v76, v77
    v_xor_b32 v77, s50, v182
    v_or_b32 v76, v76, v77
    v_xor_b32 v77, s51, v183
    v_or_b32 v76, v76, v77
    v_cmp_ne_u32 vcc, 0, v76
    s_add_u32 s61, s61, 1
    s_cmp_gt_u32 s61, 40000
    s_cbranch_scc1 L_pstd_26
    s_nop 1
    s_cbranch_vccz L_pstd_26
    s_sleep 1
    buffer_load_dwordx4 v[176:179], v4, s[12:15], s80 offen sc1
    buffer_load_dwordx4 v[180:183], v4, s[12:15], s80 offen offset:1024 sc1
    s_waitcnt vmcnt(0)
    s_branch L_pst_25
L_pstd_26:
    v_add_f32 v168, v176, v180
    v_add_f32 v169, v177, v181
    v_mov_b32 v172, v168
    v_mov_b32 v173, v169
    s_nop 0
    v_permlane16_swap_b32 v168, v172
    v_permlane16_swap_b32 v169, v173
    s_nop 0
    v_add_f32 v168, v168, v172
    v_add_f32 v169, v169, v173
    v_mov_b32 v172, v168
    v_mov_b32 v173, v169
    s_nop 0
    v_permlane32_swap_b32 v168, v172
    v_permlane32_swap_b32 v169, v173
    s_nop 0
    v_add_f32 v168, v168, v172
    v_add_f32 v169, v169, v173
    v_mul_f32 v168, 0x3b000000, v168
    v_mul_f32 v169, 0x3b000000, v169
    v_fma_f32 v169, -v168, v168, v169
    v_max_f32 v169, 0, v169
    v_cvt_pk_bf16_f32 v172, v168, v169
    v_lshlrev_b32 v168, 16, v172
    v_and_b32 v169, 0xffff0000, v172
    v_add_f32 v169, 0x3727c5ac, v169
    v_cvt_pk_bf16_f32 v169, v169, v169
    v_lshlrev_b32 v169, 16, v169
    v_sqrt_f32 v169, v169
    s_nop 0
    v_cvt_pk_bf16_f32 v169, v169, v169
    v_lshlrev_b32 v169, 16, v169
    v_rcp_f32 v169, v169
    s_nop 0
    s_waitcnt lgkmcnt(0)
    v_lshlrev_b32 v192, 16, v246
    v_and_b32 v193, 0xffff0000, v246
    v_lshlrev_b32 v194, 16, v247
    v_and_b32 v195, 0xffff0000, v247
    v_lshlrev_b32 v196, 16, v248
    v_and_b32 v197, 0xffff0000, v248
    v_lshlrev_b32 v198, 16, v249
    v_and_b32 v199, 0xffff0000, v249
    v_lshlrev_b32 v200, 16, v250
    v_and_b32 v201, 0xffff0000, v250
    v_lshlrev_b32 v202, 16, v251
    v_and_b32 v203, 0xffff0000, v251
    v_lshlrev_b32 v204, 16, v252
    v_and_b32 v205, 0xffff0000, v252
    v_lshlrev_b32 v206, 16, v253
    v_and_b32 v207, 0xffff0000, v253
    v_pk_add_f32 v[208:209], v[144:145], v[168:169] op_sel_hi:[1,0] neg_lo:[0,1] neg_hi:[0,1]
    v_pk_mul_f32 v[208:209], v[208:209], v[168:169] op_sel:[0,1]
    v_pk_fma_f32 v[208:209], v[208:209], v[192:193], v[144:145]
    v_cvt_pk_bf16_f32 v238, v208, v209
    v_pk_add_f32 v[210:211], v[146:147], v[168:169] op_sel_hi:[1,0] neg_lo:[0,1] neg_hi:[0,1]
    v_pk_mul_f32 v[210:211], v[210:211], v[168:169] op_sel:[0,1]
    v_pk_fma_f32 v[210:211], v[210:211], v[194:195], v[146:147]
    v_cvt_pk_bf16_f32 v239, v210, v211
    v_pk_add_f32 v[212:213], v[148:149], v[168:169] op_sel_hi:[1,0] neg_lo:[0,1] neg_hi:[0,1]
    v_pk_mul_f32 v[212:213], v[212:213], v[168:169] op_sel:[0,1]
    v_pk_fma_f32 v[212:213], v[212:213], v[196:197], v[148:149]
    v_cvt_pk_bf16_f32 v240, v212, v213
    v_pk_add_f32 v[214:215], v[150:151], v[168:169] op_sel_hi:[1,0] neg_lo:[0,1] neg_hi:[0,1]
    v_pk_mul_f32 v[214:215], v[214:215], v[168:169] op_sel:[0,1]
    v_pk_fma_f32 v[214:215], v[214:215], v[198:199], v[150:151]
    v_cvt_pk_bf16_f32 v241, v214, v215
    v_pk_add_f32 v[216:217], v[152:153], v[168:169] op_sel_hi:[1,0] neg_lo:[0,1] neg_hi:[0,1]
    v_pk_mul_f32 v[216:217], v[216:217], v[168:169] op_sel:[0,1]
    v_pk_fma_f32 v[216:217], v[216:217], v[200:201], v[152:153]
    v_cvt_pk_bf16_f32 v242, v216, v217
    v_pk_add_f32 v[218:219], v[154:155], v[168:169] op_sel_hi:[1,0] neg_lo:[0,1] neg_hi:[0,1]
    v_pk_mul_f32 v[218:219], v[218:219], v[168:169] op_sel:[0,1]
    v_pk_fma_f32 v[218:219], v[218:219], v[202:203], v[154:155]
    v_cvt_pk_bf16_f32 v243, v218, v219
    v_pk_add_f32 v[220:221], v[156:157], v[168:169] op_sel_hi:[1,0] neg_lo:[0,1] neg_hi:[0,1]
    v_pk_mul_f32 v[220:221], v[220:221], v[168:169] op_sel:[0,1]
    v_pk_fma_f32 v[220:221], v[220:221], v[204:205], v[156:157]
    v_cvt_pk_bf16_f32 v244, v220, v221
    v_pk_add_f32 v[222:223], v[158:159], v[168:169] op_sel_hi:[1,0] neg_lo:[0,1] neg_hi:[0,1]
    v_pk_mul_f32 v[222:223], v[222:223], v[168:169] op_sel:[0,1]
    v_pk_fma_f32 v[222:223], v[222:223], v[206:207], v[158:159]
    v_cvt_pk_bf16_f32 v245, v222, v223
    v_mov_b32 v208, v238
    v_mov_b32 v209, v239
    v_mov_b32 v210, v240
    v_mov_b32 v211, v241
    v_mov_b32 v212, v242
    v_mov_b32 v213, v243
    v_mov_b32 v214, v244
    v_mov_b32 v215, v245
    v_and_b32 v237, 1, v3
    v_lshlrev_b32 v237, 5, v237
    v_lshl_add_u32 v237, v2, 11, v237
    v_lshrrev_b32 v76, 1, v3
    v_lshl_add_u32 v237, v76, 4, v237
    v_permlane16_swap_b32 v208, v210
    v_permlane16_swap_b32 v209, v211
    v_permlane16_swap_b32 v212, v214
    v_permlane16_swap_b32 v213, v215
    s_nop 0
    s_add_u32 s79, s79, 4194304
    v_mov_b32 v168, 0
    v_mov_b32 v169, 0
    s_cmp_eq_u32 s52, 0
    s_cbranch_scc1 L_sg_27
    buffer_store_dwordx4 v[208:211], v237, s[12:15], s79 offen offset:0
    buffer_store_dwordx4 v[212:215], v237, s[12:15], s79 offen offset:64
    s_branch L_sj_28
L_sg_27:
    buffer_store_dwordx4 v[208:211], v237, s[12:15], s79 offen offset:0 sc1
    buffer_store_dwordx4 v[212:215], v237, s[12:15], s79 offen offset:64 sc1
L_sj_28:
    v_dot2_f32_bf16 v168, v238, v54, v168
    v_dot2_f32_bf16 v169, v238, v238, v169
    v_dot2_f32_bf16 v168, v239, v54, v168
    v_dot2_f32_bf16 v169, v239, v239, v169
    v_dot2_f32_bf16 v168, v240, v54, v168
    v_dot2_f32_bf16 v169, v240, v240, v169
    v_dot2_f32_bf16 v168, v241, v54, v168
    v_dot2_f32_bf16 v169, v241, v241, v169
    v_dot2_f32_bf16 v168, v242, v54, v168
    v_dot2_f32_bf16 v169, v242, v242, v169
    v_dot2_f32_bf16 v168, v243, v54, v168
    v_dot2_f32_bf16 v169, v243, v243, v169
    v_dot2_f32_bf16 v168, v244, v54, v168
    v_dot2_f32_bf16 v169, v244, v244, v169
    v_dot2_f32_bf16 v168, v245, v54, v168
    v_dot2_f32_bf16 v169, v245, v245, v169
    s_lshl_b32 s74, s45, 12
    s_lshl_b32 s75, s44, 10
    s_add_u32 s74, s74, s75
    s_lshl_b32 s75, s46, 7
    s_add_u32 s74, s74, s75
    s_add_u32 s74, s74, 11010048
    v_mov_b32 v172, v168
    v_mov_b32 v173, v169
    s_nop 0
    v_permlane16_swap_b32 v168, v172
    v_permlane16_swap_b32 v169, v173
    s_nop 0
    v_add_f32 v168, v168, v172
    v_add_f32 v169, v169, v173
    v_mov_b32 v172, v168
    v_mov_b32 v173, v169
    s_nop 0
    v_permlane32_swap_b32 v168, v172
    v_permlane32_swap_b32 v169, v173
    s_nop 0
    v_add_f32 v168, v168, v172
    v_add_f32 v169, v169, v173
    s_mov_b64 exec, 0xffff
    s_cmp_eq_u32 s52, 0
    s_cbranch_scc1 L_sg_29
    buffer_store_dwordx2 v[168:169], v35, s[12:15], s74 offen
    s_branch L_sj_30
L_sg_29:
    buffer_store_dwordx2 v[168:169], v35, s[12:15], s74 offen sc1
L_sj_30:
    s_mov_b64 exec, -1
    s_waitcnt vmcnt(0)
    s_add_u32 s74, s18, 11442176
    s_mov_b64 exec, 1
    s_cmp_eq_u32 s52, 0
    s_cbranch_scc1 L_sg_31
    buffer_store_dwordx2 v[36:37], v9, s[12:15], s74 offen
    s_branch L_sj_32
L_sg_31:
    buffer_store_dwordx2 v[36:37], v9, s[12:15], s74 offen sc1
L_sj_32:
    s_mov_b64 exec, -1
    s_cmp_lg_u32 s44, 3
    s_cbranch_scc1 L_nh_33
    v_lshrrev_b32 v75, 1, v237
    v_and_b32 v75, 0xfc00, v75
    v_and_b32 v76, 0x30, v237
    v_or_b32 v75, v75, v76
    s_lshl_b32 s74, s45, 13
    s_lshl_b32 s75, s46, 7
    s_add_u32 s74, s74, s75
    s_add_u32 s74, s74, 11132928
    s_lshl_b32 s76, s45, 9
    s_lshl_b32 s75, s46, 6
    s_add_u32 s76, s76, s75
    s_add_u32 s76, s76, 11403200
    s_mov_b32 s82, 0xff00ff00
    s_mov_b32 s83, 0xff00ff00
    s_mov_b64 exec, s[82:83]
    buffer_store_dwordx4 v[208:211], v75, s[12:15], s74 offen offset:0 sc1
    buffer_store_dwordx4 v[212:215], v75, s[12:15], s74 offen offset:64 sc1
    s_mov_b64 exec, 0xff00
    buffer_store_dwordx2 v[168:169], v35, s[12:15], s76 offen sc1
    s_mov_b64 exec, -1
L_nh_33:
    s_lshl_b32 s82, s45, 8
    s_add_u32 s82, s82, 11442176
    buffer_load_dwordx2 v[232:233], v236, s[12:15], s82 offen sc1
    s_add_u32 s62, s62, 4194304
    s_add_u32 s63, s63, 4194304
    s_add_u32 s64, s64, 4194304
    s_add_u32 s65, s65, 4194304
    s_waitcnt vmcnt(0)
    s_mov_b32 s61, 0
L_px2_34:
    v_xor_b32 v68, s50, v232
    v_xor_b32 v69, s51, v233
    v_or_b32 v68, v68, v69
    v_cmp_ne_u32 vcc, 0, v68
    s_add_u32 s61, s61, 1
    s_cmp_gt_u32 s61, 40000
    s_cbranch_scc1 L_px2d_35
    s_nop 1
    s_cbranch_vccz L_px2d_35
    s_sleep 1
    buffer_load_dwordx2 v[232:233], v236, s[12:15], s82 offen sc1
    s_waitcnt vmcnt(0)
    s_branch L_px2_34
L_px2d_35:
    s_cmp_lg_u32 s44, 3
    s_cbranch_scc1 L_nh2_36
    s_lshl_b32 s74, s45, 7
    s_lshl_b32 s75, s46, 3
    s_add_u32 s74, s74, s75
    s_add_u32 s74, s74, 11458560
    s_mov_b64 exec, 1
    buffer_store_dwordx2 v[36:37], v9, s[12:15], s74 offen sc1
    s_mov_b64 exec, -1
L_nh2_36:
    s_lshl_b32 s75, s45, 12
    s_lshl_b32 s76, s44, 10
    s_add_u32 s75, s75, s76
    s_add_u32 s75, s75, 11010048
    s_add_u32 m0, s66, 4096
    s_add_u32 s74, s62, 32768
    buffer_load_dwordx4 v5, s[12:15], s74 offen sc1 lds
    s_add_u32 m0, s66, 8192
    s_add_u32 s74, s62, 65536
    buffer_load_dwordx4 v5, s[12:15], s74 offen sc1 lds
    s_add_u32 m0, s66, 12288
    s_add_u32 s74, s62, 98304
    buffer_load_dwordx4 v5, s[12:15], s74 offen sc1 lds
    s_add_u32 m0, s66, 16384
    s_add_u32 s74, s62, 131072
    buffer_load_dwordx4 v5, s[12:15], s74 offen sc1 lds
    buffer_load_dwordx2 v[184:185], v35, s[12:15], s75 offen sc1
    buffer_load_dwordx2 v[186:187], v35, s[12:15], s75 offen offset:512 sc1
    s_add_u32 m0, s67, 4096
    s_add_u32 s74, s63, 32768
    buffer_load_dwordx4 v5, s[12:15], s74 offen sc1 lds
    s_add_u32 m0, s67, 8192
    s_add_u32 s74, s63, 65536
    buffer_load_dwordx4 v5, s[12:15], s74 offen sc1 lds
    s_add_u32 m0, s67, 12288
    s_add_u32 s74, s63, 98304
    buffer_load_dwordx4 v5, s[12:15], s74 offen sc1 lds
    s_add_u32 m0, s67, 16384
    s_add_u32 s74, s63, 131072
    buffer_load_dwordx4 v5, s[12:15], s74 offen sc1 lds
    s_sub_u32 s83, s45, 1
    s_lshl_b32 s83, s83, 7
    s_add_u32 s83, s83, 11458560
    v_and_b32 v192, 0x38, v35
    s_mov_b32 s21, 0
    s_waitcnt vmcnt(6)
    s_barrier
    ds_read_b128 v[168:171], v10 offset:4096
    ds_read_b128 v[172:175], v10 offset:8192
    ds_read_b128 v[176:179], v10 offset:12288
    ds_read_b128 v[180:183], v10 offset:16384
    s_waitcnt lgkmcnt(0)
    v_mfma_f32_16x16x32_bf16 v[112:115], a[0:3], v[168:171], 0
    ds_read_b128 v[64:67], v11 offset:4096
    ds_read_b128 v[68:71], v11 offset:8192
    ds_read_b128 v[72:75], v11 offset:12288
    ds_read_b128 v[76:79], v11 offset:16384
    v_mfma_f32_16x16x32_bf16 v[132:135], a[4:7], v[168:171], 0
    s_add_u32 m0, s68, 4096
    s_add_u32 s74, s64, 32768
    buffer_load_dwordx4 v5, s[12:15], s74 offen sc1 lds
    v_mfma_f32_16x16x32_bf16 v[152:155], v[168:171], a[8:11], 0
    s_add_u32 m0, s68, 8192
    s_add_u32 s74, s64, 65536
    buffer_load_dwordx4 v5, s[12:15], s74 offen sc1 lds
    v_mfma_f32_16x16x32_bf16 v[116:119], a[0:3], v[172:175], 0
    s_add_u32 m0, s68, 12288
    s_add_u32 s74, s64, 98304
    buffer_load_dwordx4 v5, s[12:15], s74 offen sc1 lds
    v_mfma_f32_16x16x32_bf16 v[136:139], a[4:7], v[172:175], 0
    s_add_u32 m0, s68, 16384
    s_add_u32 s74, s64, 131072
    buffer_load_dwordx4 v5, s[12:15], s74 offen sc1 lds
    v_mfma_f32_16x16x32_bf16 v[156:159], v[172:175], a[8:11], 0
    v_mfma_f32_16x16x32_bf16 v[120:123], a[0:3], v[176:179], 0
    v_mfma_f32_16x16x32_bf16 v[140:143], a[4:7], v[176:179], 0
    v_mfma_f32_16x16x32_bf16 v[160:163], v[176:179], a[8:11], 0
    v_mfma_f32_16x16x32_bf16 v[124:127], a[0:3], v[180:183], 0
    v_mfma_f32_16x16x32_bf16 v[144:147], a[4:7], v[180:183], 0
    v_mfma_f32_16x16x32_bf16 v[164:167], v[180:183], a[8:11], 0
    s_waitcnt lgkmcnt(0)
    v_mfma_f32_16x16x32_bf16 v[112:115], a[12:15], v[64:67], v[112:115]
    ds_read_b128 v[168:171], v12 offset:4096
    ds_read_b128 v[172:175], v12 offset:8192
    ds_read_b128 v[176:179], v12 offset:12288
    ds_read_b128 v[180:183], v12 offset:16384
    v_mfma_f32_16x16x32_bf16 v[132:135], a[16:19], v[64:67], v[132:135]
    s_add_u32 m0, s69, 4096
    s_add_u32 s74, s65, 32768
    buffer_load_dwordx4 v5, s[12:15], s74 offen sc1 lds
    v_mfma_f32_16x16x32_bf16 v[152:155], v[64:67], a[20:23], v[152:155]
    s_add_u32 m0, s69, 8192
    s_add_u32 s74, s65, 65536
    buffer_load_dwordx4 v5, s[12:15], s74 offen sc1 lds
    v_mfma_f32_16x16x32_bf16 v[116:119], a[12:15], v[68:71], v[116:119]
    s_add_u32 m0, s69, 12288
    s_add_u32 s74, s65, 98304
    buffer_load_dwordx4 v5, s[12:15], s74 offen sc1 lds
    v_mfma_f32_16x16x32_bf16 v[136:139], a[16:19], v[68:71], v[136:139]
    s_add_u32 m0, s69, 16384
    s_add_u32 s74, s65, 131072
    buffer_load_dwordx4 v5, s[12:15], s74 offen sc1 lds
    v_mfma_f32_16x16x32_bf16 v[156:159], v[68:71], a[20:23], v[156:159]
    v_mfma_f32_16x16x32_bf16 v[120:123], a[12:15], v[72:75], v[120:123]
    v_mfma_f32_16x16x32_bf16 v[140:143], a[16:19], v[72:75], v[140:143]
    v_mfma_f32_16x16x32_bf16 v[160:163], v[72:75], a[20:23], v[160:163]
    v_mfma_f32_16x16x32_bf16 v[124:127], a[12:15], v[76:79], v[124:127]
    v_mfma_f32_16x16x32_bf16 v[144:147], a[16:19], v[76:79], v[144:147]
    v_mfma_f32_16x16x32_bf16 v[164:167], v[76:79], a[20:23], v[164:167]
    s_waitcnt lgkmcnt(0)
    v_mfma_f32_16x16x32_bf16 v[112:115], a[24:27], v[168:171], v[112:115]
    ds_read_b128 v[64:67], v13 offset:4096
    ds_read_b128 v[68:71], v13 offset:8192
    ds_read_b128 v[72:75], v13 offset:12288
    ds_read_b128 v[76:79], v13 offset:16384
    v_mfma_f32_16x16x32_bf16 v[132:135], a[28:31], v[168:171], v[132:135]
    buffer_load_dwordx2 v[190:191], v192, s[12:15], s83 offen sc1
    v_mfma_f32_16x16x32_bf16 v[152:155], v[168:171], a[32:35], v[152:155]
    s_waitcnt vmcnt(13)
    v_add_f32 v188, v184, v186
    v_mfma_f32_16x16x32_bf16 v[116:119], a[24:27], v[172:175], v[116:119]
    v_add_f32 v189, v185, v187
    v_mov_b32 v104, v188
    v_mfma_f32_16x16x32_bf16 v[136:139], a[28:31], v[172:175], v[136:139]
    v_mov_b32 v105, v189
    v_mfma_f32_16x16x32_bf16 v[156:159], v[172:175], a[32:35], v[156:159]
    v_permlane16_swap_b32 v188, v104
    v_permlane16_swap_b32 v189, v105
    v_mfma_f32_16x16x32_bf16 v[120:123], a[24:27], v[176:179], v[120:123]
    v_add_f32 v188, v188, v104
    v_add_f32 v189, v189, v105
    v_mfma_f32_16x16x32_bf16 v[140:143], a[28:31], v[176:179], v[140:143]
    v_mov_b32 v104, v188
    v_mov_b32 v105, v189
    v_mfma_f32_16x16x32_bf16 v[160:163], v[176:179], a[32:35], v[160:163]
    v_permlane32_swap_b32 v188, v104
    v_permlane32_swap_b32 v189, v105
    v_mfma_f32_16x16x32_bf16 v[124:127], a[24:27], v[180:183], v[124:127]
    v_add_f32 v188, v188, v104
    v_add_f32 v189, v189, v105
    v_mfma_f32_16x16x32_bf16 v[144:147], a[28:31], v[180:183], v[144:147]
    v_mul_f32 v188, 0x3b000000, v188
    v_mul_f32 v189, 0x3b000000, v189
    v_mfma_f32_16x16x32_bf16 v[164:167], v[180:183], a[32:35], v[164:167]
    v_fma_f32 v189, -v188, v188, v189
    v_max_f32 v189, 0, v189
    v_cvt_pk_bf16_f32 v104, v188, v189
    v_lshlrev_b32 v188, 16, v104
    v_and_b32 v189, 0xffff0000, v104
    v_add_f32 v189, 0x3727c5ac, v189
    v_cvt_pk_bf16_f32 v189, v189, v189
    v_lshlrev_b32 v189, 16, v189
    v_sqrt_f32 v189, v189
    s_nop 0
    v_cvt_pk_bf16_f32 v189, v189, v189
    v_lshlrev_b32 v189, 16, v189
    v_rcp_f32 v189, v189
    s_nop 0
    v_lshlrev_b32 v193, 3, v2
    s_lshl_b32 s77, s44, 7
    s_add_u32 s77, s77, 155776
    v_add_u32 v195, s77, v193
    ds_write_b64 v195, v[188:189]
    v_add_u32 v193, 155648, v193
    v_lshlrev_b32 v194, 5, v3
    v_add_u32 v194, 155648, v194
    s_waitcnt vmcnt(9) lgkmcnt(0)
    s_barrier
    v_mfma_f32_16x16x32_bf16 v[112:115], a[36:39], v[64:67], v[112:115]
    ds_read_b128 v[168:171], v14 offset:4096
    ds_read_b128 v[172:175], v14 offset:8192
    ds_read_b128 v[176:179], v14 offset:12288
    ds_read_b128 v[180:183], v14 offset:16384
    v_mfma_f32_16x16x32_bf16 v[132:135], a[40:43], v[64:67], v[132:135]
    v_mfma_f32_16x16x32_bf16 v[152:155], v[64:67], a[44:47], v[152:155]
    v_mfma_f32_16x16x32_bf16 v[116:119], a[36:39], v[68:71], v[116:119]
    v_mfma_f32_16x16x32_bf16 v[136:139], a[40:43], v[68:71], v[136:139]
    v_mfma_f32_16x16x32_bf16 v[156:159], v[68:71], a[44:47], v[156:159]
    v_mfma_f32_16x16x32_bf16 v[120:123], a[36:39], v[72:75], v[120:123]
    v_mfma_f32_16x16x32_bf16 v[140:143], a[40:43], v[72:75], v[140:143]
    v_mfma_f32_16x16x32_bf16 v[160:163], v[72:75], a[44:47], v[160:163]
    v_mfma_f32_16x16x32_bf16 v[124:127], a[36:39], v[76:79], v[124:127]
    v_mfma_f32_16x16x32_bf16 v[144:147], a[40:43], v[76:79], v[144:147]
    v_mfma_f32_16x16x32_bf16 v[164:167], v[76:79], a[44:47], v[164:167]
    s_waitcnt lgkmcnt(0)
    v_mfma_f32_16x16x32_bf16 v[112:115], a[48:51], v[168:171], v[112:115]
    ds_read_b128 v[64:67], v15 offset:4096
    ds_read_b128 v[68:71], v15 offset:8192
    ds_read_b128 v[72:75], v15 offset:12288
    ds_read_b128 v[76:79], v15 offset:16384
    v_mfma_f32_16x16x32_bf16 v[132:135], a[52:55], v[168:171], v[132:135]
    v_mfma_f32_16x16x32_bf16 v[152:155], v[168:171], a[56:59], v[152:155]
    v_mfma_f32_16x16x32_bf16 v[116:119], a[48:51], v[172:175], v[116:119]
    v_mfma_f32_16x16x32_bf16 v[136:139], a[52:55], v[172:175], v[136:139]
    v_mfma_f32_16x16x32_bf16 v[156:159], v[172:175], a[56:59], v[156:159]
    v_mfma_f32_16x16x32_bf16 v[120:123], a[48:51], v[176:179], v[120:123]
    v_mfma_f32_16x16x32_bf16 v[140:143], a[52:55], v[176:179], v[140:143]
    v_mfma_f32_16x16x32_bf16 v[160:163], v[176:179], a[56:59], v[160:163]
    v_mfma_f32_16x16x32_bf16 v[124:127], a[48:51], v[180:183], v[124:127]
    v_mfma_f32_16x16x32_bf16 v[144:147], a[52:55], v[180:183], v[144:147]
    v_mfma_f32_16x16x32_bf16 v[164:167], v[180:183], a[56:59], v[164:167]
    s_waitcnt lgkmcnt(0)
    v_mfma_f32_16x16x32_bf16 v[112:115], a[60:63], v[64:67], v[112:115]
    ds_read_b128 v[168:171], v16 offset:4096
    ds_read_b128 v[172:175], v16 offset:8192
    ds_read_b128 v[176:179], v16 offset:12288
    ds_read_b128 v[180:183], v16 offset:16384
    v_mfma_f32_16x16x32_bf16 v[132:135], a[64:67], v[64:67], v[132:135]
    v_mfma_f32_16x16x32_bf16 v[152:155], v[64:67], a[68:71], v[152:155]
    v_mfma_f32_16x16x32_bf16 v[116:119], a[60:63], v[68:71], v[116:119]
    v_mfma_f32_16x16x32_bf16 v[136:139], a[64:67], v[68:71], v[136:139]
    v_mfma_f32_16x16x32_bf16 v[156:159], v[68:71], a[68:71], v[156:159]
    v_mfma_f32_16x16x32_bf16 v[120:123], a[60:63], v[72:75], v[120:123]
    v_mfma_f32_16x16x32_bf16 v[140:143], a[64:67], v[72:75], v[140:143]
    v_mfma_f32_16x16x32_bf16 v[160:163], v[72:75], a[68:71], v[160:163]
    v_mfma_f32_16x16x32_bf16 v[124:127], a[60:63], v[76:79], v[124:127]
    v_mfma_f32_16x16x32_bf16 v[144:147], a[64:67], v[76:79], v[144:147]
    v_mfma_f32_16x16x32_bf16 v[164:167], v[76:79], a[68:71], v[164:167]
    s_waitcnt vmcnt(1) lgkmcnt(0)
    s_barrier
    v_mfma_f32_16x16x32_bf16 v[112:115], a[72:75], v[168:171], v[112:115]
    ds_read_b128 v[64:67], v17 offset:4096
    ds_read_b128 v[68:71], v17 offset:8192
    ds_read_b128 v[72:75], v17 offset:12288
    ds_read_b128 v[76:79], v17 offset:16384
    v_mfma_f32_16x16x32_bf16 v[132:135], a[76:79], v[168:171], v[132:135]
    v_mfma_f32_16x16x32_bf16 v[152:155], v[168:171], a[80:83], v[152:155]
    v_mfma_f32_16x16x32_bf16 v[116:119], a[72:75], v[172:175], v[116:119]
    v_mfma_f32_16x16x32_bf16 v[136:139], a[76:79], v[172:175], v[136:139]
    v_mfma_f32_16x16x32_bf16 v[156:159], v[172:175], a[80:83], v[156:159]
    v_mfma_f32_16x16x32_bf16 v[120:123], a[72:75], v[176:179], v[120:123]
    v_mfma_f32_16x16x32_bf16 v[140:143], a[76:79], v[176:179], v[140:143]
    v_mfma_f32_16x16x32_bf16 v[160:163], v[176:179], a[80:83], v[160:163]
    v_mfma_f32_16x16x32_bf16 v[124:127], a[72:75], v[180:183], v[124:127]
    v_mfma_f32_16x16x32_bf16 v[144:147], a[76:79], v[180:183], v[144:147]
    v_mfma_f32_16x16x32_bf16 v[164:167], v[180:183], a[80:83], v[164:167]
    s_waitcnt lgkmcnt(0)
    v_mfma_f32_16x16x32_bf16 v[112:115], a[84:87], v[64:67], v[112:115]
    ds_read_b128 v[168:171], v18 offset:4096
    ds_read_b128 v[172:175], v18 offset:8192
    ds_read_b128 v[176:179], v18 offset:12288
    ds_read_b128 v[180:183], v18 offset:16384
    v_mfma_f32_16x16x32_bf16 v[132:135], a[88:91], v[64:67], v[132:135]
    v_mfma_f32_16x16x32_bf16 v[152:155], v[64:67], a[92:95], v[152:155]
    v_mfma_f32_16x16x32_bf16 v[116:119], a[84:87], v[68:71], v[116:119]
    v_mfma_f32_16x16x32_bf16 v[136:139], a[88:91], v[68:71], v[136:139]
    v_mfma_f32_16x16x32_bf16 v[156:159], v[68:71], a[92:95], v[156:159]
    v_mfma_f32_16x16x32_bf16 v[120:123], a[84:87], v[72:75], v[120:123]
    v_mfma_f32_16x16x32_bf16 v[140:143], a[88:91], v[72:75], v[140:143]
    v_mfma_f32_16x16x32_bf16 v[160:163], v[72:75], a[92:95], v[160:163]
    v_mfma_f32_16x16x32_bf16 v[124:127], a[84:87], v[76:79], v[124:127]
    v_mfma_f32_16x16x32_bf16 v[144:147], a[88:91], v[76:79], v[144:147]
    v_mfma_f32_16x16x32_bf16 v[164:167], v[76:79], a[92:95], v[164:167]
    s_cmp_lg_u32 s21, 0
    s_cbranch_scc1 L_hskip_37
    s_cmp_eq_u32 s48, 0
    s_cbranch_scc1 L_hgo_38
    s_waitcnt vmcnt(0)
    v_xor_b32 v184, s50, v190
    v_xor_b32 v185, s51, v191
    v_or_b32 v184, v184, v185
    v_cmp_ne_u32 vcc, 0, v184
    s_nop 4
    s_cbranch_vccnz L_hskip_37
L_hgo_38:
    s_mov_b32 s21, 1
    v_lshrrev_b32 v184, 11, v5
    v_and_b32 v185, 0xff, v5
    v_lshl_add_u32 v184, v184, 10, v185
    s_lshl_b32 s76, s44, 10
    s_lshl_b32 s74, s45, 13
    s_lshl_b32 s75, s44, 12
    s_add_u32 s74, s74, s75
    s_add_u32 s74, s74, 11124736
    s_cmp_lt_u32 s44, 2
    s_cselect_b32 s74, 2146435072, s74
    s_cmp_eq_u32 s48, 0
    s_cselect_b32 s74, 2146435072, s74
    s_add_u32 m0, s76, 0
    s_add_u32 s75, s74, 0
    buffer_load_dwordx4 v184, s[12:15], s75 offen sc1 lds
    s_add_u32 m0, s76, 20480
    s_add_u32 s75, s74, 256
    buffer_load_dwordx4 v184, s[12:15], s75 offen sc1 lds
    s_add_u32 m0, s76, 40960
    s_add_u32 s75, s74, 512
    buffer_load_dwordx4 v184, s[12:15], s75 offen sc1 lds
    s_add_u32 m0, s76, 61440
    s_add_u32 s75, s74, 768
    buffer_load_dwordx4 v184, s[12:15], s75 offen sc1 lds
    v_and_b32 v185, 7, v2
    v_lshlrev_b32 v185, 3, v185
    v_lshl_add_u32 v195, v3, 6, v185
    s_lshl_b32 s74, s45, 9
    s_add_u32 s74, s74, 11402752
    s_cmp_eq_u32 s48, 0
    s_cselect_b32 s74, 2146435072, s74
    s_nop 1
    buffer_load_dwordx2 v[184:185], v195, s[12:15], s74 offen sc1
    buffer_load_dwordx2 v[186:187], v195, s[12:15], s74 offen offset:256 sc1
L_hskip_37:
    buffer_load_dwordx2 v[190:191], v192, s[12:15], s83 offen sc1
    s_waitcnt lgkmcnt(0)
    v_mfma_f32_16x16x32_bf16 v[112:115], a[96:99], v[168:171], v[112:115]
    ds_read_b128 v[64:67], v19 offset:4096
    ds_read_b128 v[68:71], v19 offset:8192
    ds_read_b128 v[72:75], v19 offset:12288
    ds_read_b128 v[76:79], v19 offset:16384
    v_mfma_f32_16x16x32_bf16 v[132:135], a[100:103], v[168:171], v[132:135]
    ds_read_b64 v[96:97], v193 offset:128
    ds_read_b128 v[204:207], v194 offset:128
    ds_read_b128 v[208:211], v194 offset:144
    v_mfma_f32_16x16x32_bf16 v[152:155], v[168:171], a[104:107], v[152:155]
    v_mfma_f32_16x16x32_bf16 v[116:119], a[96:99], v[172:175], v[116:119]
    v_mfma_f32_16x16x32_bf16 v[136:139], a[100:103], v[172:175], v[136:139]
    v_mfma_f32_16x16x32_bf16 v[156:159], v[172:175], a[104:107], v[156:159]
    v_mfma_f32_16x16x32_bf16 v[120:123], a[96:99], v[176:179], v[120:123]
    v_mfma_f32_16x16x32_bf16 v[140:143], a[100:103], v[176:179], v[140:143]
    v_mfma_f32_16x16x32_bf16 v[160:163], v[176:179], a[104:107], v[160:163]
    v_mfma_f32_16x16x32_bf16 v[124:127], a[96:99], v[180:183], v[124:127]
    v_mfma_f32_16x16x32_bf16 v[144:147], a[100:103], v[180:183], v[144:147]
    v_mfma_f32_16x16x32_bf16 v[164:167], v[180:183], a[104:107], v[164:167]
    s_waitcnt lgkmcnt(0)
    v_mfma_f32_16x16x32_bf16 v[112:115], a[108:111], v[64:67], v[112:115]
    ds_read_b128 v[168:171], v20 offset:4096
    ds_read_b128 v[172:175], v20 offset:8192
    ds_read_b128 v[176:179], v20 offset:12288
    ds_read_b128 v[180:183], v20 offset:16384
    v_mfma_f32_16x16x32_bf16 v[132:135], a[112:115], v[64:67], v[132:135]
    ds_read_b64 v[98:99], v193 offset:256
    ds_read_b128 v[212:215], v194 offset:256
    ds_read_b128 v[216:219], v194 offset:272
    v_mfma_f32_16x16x32_bf16 v[152:155], v[64:67], a[116:119], v[152:155]
    v_mfma_f32_16x16x32_bf16 v[116:119], a[108:111], v[68:71], v[116:119]
    v_mfma_f32_16x16x32_bf16 v[136:139], a[112:115], v[68:71], v[136:139]
    v_mfma_f32_16x16x32_bf16 v[156:159], v[68:71], a[116:119], v[156:159]
    v_mfma_f32_16x16x32_bf16 v[120:123], a[108:111], v[72:75], v[120:123]
    v_mfma_f32_16x16x32_bf16 v[140:143], a[112:115], v[72:75], v[140:143]
    v_mfma_f32_16x16x32_bf16 v[160:163], v[72:75], a[116:119], v[160:163]
    v_mfma_f32_16x16x32_bf16 v[124:127], a[108:111], v[76:79], v[124:127]
    v_mfma_f32_16x16x32_bf16 v[144:147], a[112:115], v[76:79], v[144:147]
    v_mfma_f32_16x16x32_bf16 v[164:167], v[76:79], a[116:119], v[164:167]
    s_waitcnt lgkmcnt(0)
    v_mfma_f32_16x16x32_bf16 v[112:115], a[120:123], v[168:171], v[112:115]
    ds_read_b128 v[64:67], v21 offset:4096
    ds_read_b128 v[68:71], v21 offset:8192
    ds_read_b128 v[72:75], v21 offset:12288
    ds_read_b128 v[76:79], v21 offset:16384
    v_mfma_f32_16x16x32_bf16 v[132:135], a[124:127], v[168:171], v[132:135]
    ds_read_b64 v[100:101], v193 offset:384
    ds_read_b128 v[220:223], v194 offset:384
    ds_read_b128 v[224:227], v194 offset:400
    v_mfma_f32_16x16x32_bf16 v[152:155], v[168:171], a[128:131], v[152:155]
    v_mfma_f32_16x16x32_bf16 v[116:119], a[120:123], v[172:175], v[116:119]
    v_mfma_f32_16x16x32_bf16 v[136:139], a[124:127], v[172:175], v[136:139]
    v_mfma_f32_16x16x32_bf16 v[156:159], v[172:175], a[128:131], v[156:159]
    v_mfma_f32_16x16x32_bf16 v[120:123], a[120:123], v[176:179], v[120:123]
    v_mfma_f32_16x16x32_bf16 v[140:143], a[124:127], v[176:179], v[140:143]
    v_mfma_f32_16x16x32_bf16 v[160:163], v[176:179], a[128:131], v[160:163]
    v_mfma_f32_16x16x32_bf16 v[124:127], a[120:123], v[180:183], v[124:127]
    v_mfma_f32_16x16x32_bf16 v[144:147], a[124:127], v[180:183], v[144:147]
    v_mfma_f32_16x16x32_bf16 v[164:167], v[180:183], a[128:131], v[164:167]
    s_waitcnt lgkmcnt(0)
    v_mfma_f32_16x16x32_bf16 v[112:115], a[132:135], v[64:67], v[112:115]
    ds_read_b128 v[168:171], v22 offset:4096
    ds_read_b128 v[172:175], v22 offset:8192
    ds_read_b128 v[176:179], v22 offset:12288
    ds_read_b128 v[180:183], v22 offset:16384
    v_mfma_f32_16x16x32_bf16 v[132:135], a[136:139], v[64:67], v[132:135]
    ds_read_b64 v[102:103], v193 offset:512
    ds_read_b128 v[228:231], v194 offset:512
    ds_read_b128 v[232:235], v194 offset:528
    v_mfma_f32_16x16x32_bf16 v[152:155], v[64:67], a[140:143], v[152:155]
    v_mfma_f32_16x16x32_bf16 v[116:119], a[132:135], v[68:71], v[116:119]
    v_mfma_f32_16x16x32_bf16 v[136:139], a[136:139], v[68:71], v[136:139]
    v_mfma_f32_16x16x32_bf16 v[156:159], v[68:71], a[140:143], v[156:159]
    v_mfma_f32_16x16x32_bf16 v[120:123], a[132:135], v[72:75], v[120:123]
    v_mfma_f32_16x16x32_bf16 v[140:143], a[136:139], v[72:75], v[140:143]
    v_mfma_f32_16x16x32_bf16 v[160:163], v[72:75], a[140:143], v[160:163]
    v_mfma_f32_16x16x32_bf16 v[124:127], a[132:135], v[76:79], v[124:127]
    v_mfma_f32_16x16x32_bf16 v[144:147], a[136:139], v[76:79], v[144:147]
    v_mfma_f32_16x16x32_bf16 v[164:167], v[76:79], a[140:143], v[164:167]
    s_waitcnt lgkmcnt(0)
    v_mfma_f32_16x16x32_bf16 v[112:115], a[144:147], v[168:171], v[112:115]
    ds_read_b128 v[64:67], v23 offset:4096
    ds_read_b128 v[68:71], v23 offset:8192
    ds_read_b128 v[72:75], v23 offset:12288
    ds_read_b128 v[76:79], v23 offset:16384
    v_mfma_f32_16x16x32_bf16 v[132:135], a[148:151], v[168:171], v[132:135]
    v_mfma_f32_16x16x32_bf16 v[152:155], v[168:171], a[152:155], v[152:155]
    v_mfma_f32_16x16x32_bf16 v[116:119], a[144:147], v[172:175], v[116:119]
    v_mfma_f32_16x16x32_bf16 v[136:139], a[148:151], v[172:175], v[136:139]
    v_mfma_f32_16x16x32_bf16 v[156:159], v[172:175], a[152:155], v[156:159]
    v_mfma_f32_16x16x32_bf16 v[120:123], a[144:147], v[176:179], v[120:123]
    v_mfma_f32_16x16x32_bf16 v[140:143], a[148:151], v[176:179], v[140:143]
    v_mfma_f32_16x16x32_bf16 v[160:163], v[176:179], a[152:155], v[160:163]
    v_mfma_f32_16x16x32_bf16 v[124:127], a[144:147], v[180:183], v[124:127]
    v_mfma_f32_16x16x32_bf16 v[144:147], a[148:151], v[180:183], v[144:147]
    v_mfma_f32_16x16x32_bf16 v[164:167], v[180:183], a[152:155], v[164:167]
    s_cmp_lg_u32 s21, 0
    s_cbranch_scc1 L_hskip_39
    s_cmp_eq_u32 s48, 0
    s_cbranch_scc1 L_hgo_40
    s_waitcnt vmcnt(0)
    v_xor_b32 v184, s50, v190
    v_xor_b32 v185, s51, v191
    v_or_b32 v184, v184, v185
    v_cmp_ne_u32 vcc, 0, v184
    s_nop 4
    s_cbranch_vccnz L_hskip_39
L_hgo_40:
    s_mov_b32 s21, 1
    v_lshrrev_b32 v184, 11, v5
    v_and_b32 v185, 0xff, v5
    v_lshl_add_u32 v184, v184, 10, v185
    s_lshl_b32 s76, s44, 10
    s_lshl_b32 s74, s45, 13
    s_lshl_b32 s75, s44, 12
    s_add_u32 s74, s74, s75
    s_add_u32 s74, s74, 11124736
    s_cmp_lt_u32 s44, 2
    s_cselect_b32 s74, 2146435072, s74
    s_cmp_eq_u32 s48, 0
    s_cselect_b32 s74, 2146435072, s74
    s_add_u32 m0, s76, 0
    s_add_u32 s75, s74, 0
    buffer_load_dwordx4 v184, s[12:15], s75 offen sc1 lds
    s_add_u32 m0, s76, 20480
    s_add_u32 s75, s74, 256
    buffer_load_dwordx4 v184, s[12:15], s75 offen sc1 lds
    s_add_u32 m0, s76, 40960
    s_add_u32 s75, s74, 512
    buffer_load_dwordx4 v184, s[12:15], s75 offen sc1 lds
    s_add_u32 m0, s76, 61440
    s_add_u32 s75, s74, 768
    buffer_load_dwordx4 v184, s[12:15], s75 offen sc1 lds
    v_and_b32 v185, 7, v2
    v_lshlrev_b32 v185, 3, v185
    v_lshl_add_u32 v195, v3, 6, v185
    s_lshl_b32 s74, s45, 9
    s_add_u32 s74, s74, 11402752
    s_cmp_eq_u32 s48, 0
    s_cselect_b32 s74, 2146435072, s74
    s_nop 1
    buffer_load_dwordx2 v[184:185], v195, s[12:15], s74 offen sc1
    buffer_load_dwordx2 v[186:187], v195, s[12:15], s74 offen offset:256 sc1
L_hskip_39:
    buffer_load_dwordx2 v[190:191], v192, s[12:15], s83 offen sc1
    s_waitcnt lgkmcnt(0)
    v_mfma_f32_16x16x32_bf16 v[112:115], a[156:159], v[64:67], v[112:115]
    ds_read_b128 v[168:171], v24 offset:4096
    ds_read_b128 v[172:175], v24 offset:8192
    ds_read_b128 v[176:179], v24 offset:12288
    ds_read_b128 v[180:183], v24 offset:16384
    v_mfma_f32_16x16x32_bf16 v[132:135], a[160:163], v[64:67], v[132:135]
    v_mfma_f32_16x16x32_bf16 v[152:155], v[64:67], a[164:167], v[152:155]
    v_mfma_f32_16x16x32_bf16 v[116:119], a[156:159], v[68:71], v[116:119]
    v_mfma_f32_16x16x32_bf16 v[136:139], a[160:163], v[68:71], v[136:139]
    v_mfma_f32_16x16x32_bf16 v[156:159], v[68:71], a[164:167], v[156:159]
    v_mfma_f32_16x16x32_bf16 v[120:123], a[156:159], v[72:75], v[120:123]
    v_mfma_f32_16x16x32_bf16 v[140:143], a[160:163], v[72:75], v[140:143]
    v_mfma_f32_16x16x32_bf16 v[160:163], v[72:75], a[164:167], v[160:163]
    v_mfma_f32_16x16x32_bf16 v[124:127], a[156:159], v[76:79], v[124:127]
    v_mfma_f32_16x16x32_bf16 v[144:147], a[160:163], v[76:79], v[144:147]
    v_mfma_f32_16x16x32_bf16 v[164:167], v[76:79], a[164:167], v[164:167]
    s_waitcnt lgkmcnt(0)
    v_mfma_f32_16x16x32_bf16 v[112:115], a[168:171], v[168:171], v[112:115]
    ds_read_b128 v[64:67], v25 offset:4096
    ds_read_b128 v[68:71], v25 offset:8192
    ds_read_b128 v[72:75], v25 offset:12288
    ds_read_b128 v[76:79], v25 offset:16384
    v_mfma_f32_16x16x32_bf16 v[132:135], a[172:175], v[168:171], v[132:135]
    v_mfma_f32_16x16x32_bf16 v[152:155], v[168:171], a[176:179], v[152:155]
    v_mfma_f32_16x16x32_bf16 v[116:119], a[168:171], v[172:175], v[116:119]
    v_mfma_f32_16x16x32_bf16 v[136:139], a[172:175], v[172:175], v[136:139]
    v_mfma_f32_16x16x32_bf16 v[156:159], v[172:175], a[176:179], v[156:159]
    v_mfma_f32_16x16x32_bf16 v[120:123], a[168:171], v[176:179], v[120:123]
    v_mfma_f32_16x16x32_bf16 v[140:143], a[172:175], v[176:179], v[140:143]
    v_mfma_f32_16x16x32_bf16 v[160:163], v[176:179], a[176:179], v[160:163]
    v_mfma_f32_16x16x32_bf16 v[124:127], a[168:171], v[180:183], v[124:127]
    v_mfma_f32_16x16x32_bf16 v[144:147], a[172:175], v[180:183], v[144:147]
    v_mfma_f32_16x16x32_bf16 v[164:167], v[180:183], a[176:179], v[164:167]
    s_waitcnt lgkmcnt(0)
    v_mfma_f32_16x16x32_bf16 v[112:115], a[180:183], v[64:67], v[112:115]
    v_mfma_f32_16x16x32_bf16 v[132:135], a[184:187], v[64:67], v[132:135]
    v_mfma_f32_16x16x32_bf16 v[152:155], v[64:67], a[188:191], v[152:155]
    v_mfma_f32_16x16x32_bf16 v[116:119], a[180:183], v[68:71], v[116:119]
    v_mfma_f32_16x16x32_bf16 v[136:139], a[184:187], v[68:71], v[136:139]
    v_mfma_f32_16x16x32_bf16 v[156:159], v[68:71], a[188:191], v[156:159]
    v_mfma_f32_16x16x32_bf16 v[120:123], a[180:183], v[72:75], v[120:123]
    v_mfma_f32_16x16x32_bf16 v[140:143], a[184:187], v[72:75], v[140:143]
    v_mfma_f32_16x16x32_bf16 v[160:163], v[72:75], a[188:191], v[160:163]
    v_mfma_f32_16x16x32_bf16 v[124:127], a[180:183], v[76:79], v[124:127]
    v_mfma_f32_16x16x32_bf16 v[144:147], a[184:187], v[76:79], v[144:147]
    v_mfma_f32_16x16x32_bf16 v[164:167], v[76:79], a[188:191], v[164:167]
    s_cmp_lg_u32 s21, 0
    s_cbranch_scc1 L_hskip_41
    s_cmp_eq_u32 s48, 0
    s_cbranch_scc1 L_hgo_42
    s_waitcnt vmcnt(0)
    s_mov_b32 s61, 0
L_ph_43:
    v_xor_b32 v184, s50, v190
    v_xor_b32 v185, s51, v191
    v_or_b32 v184, v184, v185
    v_cmp_ne_u32 vcc, 0, v184
    s_add_u32 s61, s61, 1
    s_cmp_gt_u32 s61, 40000
    s_cbranch_scc1 L_phd_44
    s_nop 1
    s_cbranch_vccz L_phd_44
    s_sleep 2
    buffer_load_dwordx2 v[190:191], v192, s[12:15], s83 offen sc1
    s_waitcnt vmcnt(0)
    s_branch L_ph_43
L_phd_44:
L_hgo_42:
    s_mov_b32 s21, 1
    v_lshrrev_b32 v184, 11, v5
    v_and_b32 v185, 0xff, v5
    v_lshl_add_u32 v184, v184, 10, v185
    s_lshl_b32 s76, s44, 10
    s_lshl_b32 s74, s45, 13
    s_lshl_b32 s75, s44, 12
    s_add_u32 s74, s74, s75
    s_add_u32 s74, s74, 11124736
    s_cmp_lt_u32 s44, 2
    s_cselect_b32 s74, 2146435072, s74
    s_cmp_eq_u32 s48, 0
    s_cselect_b32 s74, 2146435072, s74
    s_add_u32 m0, s76, 0
    s_add_u32 s75, s74, 0
    buffer_load_dwordx4 v184, s[12:15], s75 offen sc1 lds
    s_add_u32 m0, s76, 20480
    s_add_u32 s75, s74, 256
    buffer_load_dwordx4 v184, s[12:15], s75 offen sc1 lds
    s_add_u32 m0, s76, 40960
    s_add_u32 s75, s74, 512
    buffer_load_dwordx4 v184, s[12:15], s75 offen sc1 lds
    s_add_u32 m0, s76, 61440
    s_add_u32 s75, s74, 768
    buffer_load_dwordx4 v184, s[12:15], s75 offen sc1 lds
    v_and_b32 v185, 7, v2
    v_lshlrev_b32 v185, 3, v185
    v_lshl_add_u32 v195, v3, 6, v185
    s_lshl_b32 s74, s45, 9
    s_add_u32 s74, s74, 11402752
    s_cmp_eq_u32 s48, 0
    s_cselect_b32 s74, 2146435072, s74
    s_nop 1
    buffer_load_dwordx2 v[184:185], v195, s[12:15], s74 offen sc1
    buffer_load_dwordx2 v[186:187], v195, s[12:15], s74 offen offset:256 sc1
L_hskip_41:
    s_waitcnt vmcnt(0)
    s_barrier
    ds_read_b128 v[168:171], v10 offset:0
    ds_read_b128 v[172:175], v11 offset:0
    ds_read_b128 v[176:179], v12 offset:0
    ds_read_b128 v[180:183], v13 offset:0
    s_waitcnt lgkmcnt(2)
    v_mfma_f32_16x16x32_bf16 v[128:131], a[4:7], v[168:171], 0
    v_add_f32 v188, v184, v186
    v_add_f32 v189, v185, v187
    v_mfma_f32_16x16x32_bf16 v[148:151], v[168:171], a[8:11], 0
    v_mov_b32 v184, v188
    v_mov_b32 v185, v189
    v_mfma_f32_16x16x32_bf16 v[128:131], a[16:19], v[172:175], v[128:131]
    v_permlane16_swap_b32 v188, v184
    v_permlane16_swap_b32 v189, v185
    v_mfma_f32_16x16x32_bf16 v[148:151], v[172:175], a[20:23], v[148:151]
    v_add_f32 v188, v188, v184
    v_add_f32 v189, v189, v185
    ds_read_b128 v[168:171], v14 offset:0
    ds_read_b128 v[172:175], v15 offset:0
    s_waitcnt lgkmcnt(2)
    v_mfma_f32_16x16x32_bf16 v[128:131], a[28:31], v[176:179], v[128:131]
    v_mov_b32 v184, v188
    v_mov_b32 v185, v189
    v_mfma_f32_16x16x32_bf16 v[148:151], v[176:179], a[32:35], v[148:151]
    v_permlane32_swap_b32 v188, v184
    v_permlane32_swap_b32 v189, v185
    v_mfma_f32_16x16x32_bf16 v[128:131], a[40:43], v[180:183], v[128:131]
    v_add_f32 v188, v188, v184
    v_add_f32 v189, v189, v185
    v_mfma_f32_16x16x32_bf16 v[148:151], v[180:183], a[44:47], v[148:151]
    v_mul_f32 v188, 0x3b000000, v188
    v_mul_f32 v189, 0x3b000000, v189
    ds_read_b128 v[176:179], v16 offset:0
    ds_read_b128 v[180:183], v17 offset:0
    s_waitcnt lgkmcnt(2)
    v_mfma_f32_16x16x32_bf16 v[128:131], a[52:55], v[168:171], v[128:131]
    v_fma_f32 v189, -v188, v188, v189
    v_max_f32 v189, 0, v189
    v_mfma_f32_16x16x32_bf16 v[148:151], v[168:171], a[56:59], v[148:151]
    v_cvt_pk_bf16_f32 v184, v188, v189
    v_lshlrev_b32 v188, 16, v184
    v_mfma_f32_16x16x32_bf16 v[128:131], a[64:67], v[172:175], v[128:131]
    v_and_b32 v189, 0xffff0000, v184
    v_add_f32 v189, 0x3727c5ac, v189
    v_mfma_f32_16x16x32_bf16 v[148:151], v[172:175], a[68:71], v[148:151]
    v_cvt_pk_bf16_f32 v189, v189, v189
    v_lshlrev_b32 v189, 16, v189
    ds_read_b128 v[168:171], v18 offset:0
    ds_read_b128 v[172:175], v19 offset:0
    s_waitcnt lgkmcnt(2)
    v_mfma_f32_16x16x32_bf16 v[128:131], a[76:79], v[176:179], v[128:131]
    v_sqrt_f32 v189, v189
    v_mfma_f32_16x16x32_bf16 v[148:151], v[176:179], a[80:83], v[148:151]
    v_cvt_pk_bf16_f32 v189, v189, v189
    v_lshlrev_b32 v189, 16, v189
    v_mfma_f32_16x16x32_bf16 v[128:131], a[88:91], v[180:183], v[128:131]
    v_rcp_f32 v189, v189
    v_mfma_f32_16x16x32_bf16 v[148:151], v[180:183], a[92:95], v[148:151]
    v_and_b32 v184, 0x38, v193
    v_add_u32 v184, 155712, v184
    ds_read_b128 v[176:179], v20 offset:0
    ds_read_b128 v[180:183], v21 offset:0
    s_waitcnt lgkmcnt(2)
    v_mfma_f32_16x16x32_bf16 v[128:131], a[100:103], v[168:171], v[128:131]
    v_fma_f32 v112, -v96, v26, v112
    v_fma_f32 v113, -v96, v27, v113
    v_mfma_f32_16x16x32_bf16 v[148:151], v[168:171], a[104:107], v[148:151]
    v_fma_f32 v114, -v96, v28, v114
    v_fma_f32 v115, -v96, v29, v115
    v_mfma_f32_16x16x32_bf16 v[128:131], a[112:115], v[172:175], v[128:131]
    v_mul_f32 v112, v97, v112
    v_mul_f32 v113, v97, v113
    v_mfma_f32_16x16x32_bf16 v[148:151], v[172:175], a[116:119], v[148:151]
    v_mul_f32 v114, v97, v114
    v_mul_f32 v115, v97, v115
    ds_read_b128 v[168:171], v22 offset:0
    ds_read_b128 v[172:175], v23 offset:0
    s_waitcnt lgkmcnt(2)
    v_mfma_f32_16x16x32_bf16 v[128:131], a[124:127], v[176:179], v[128:131]
    v_cvt_pk_bf16_f32 v66, v112, v113
    v_cvt_pk_bf16_f32 v67, v114, v115
    v_mfma_f32_16x16x32_bf16 v[148:151], v[176:179], a[128:131], v[148:151]
    v_fma_f32 v132, -v96, v30, v132
    v_fma_f32 v133, -v96, v31, v133
    v_mfma_f32_16x16x32_bf16 v[128:131], a[136:139], v[180:183], v[128:131]
    v_fma_f32 v134, -v96, v32, v134
    v_fma_f32 v135, -v96, v33, v135
    v_mfma_f32_16x16x32_bf16 v[148:151], v[180:183], a[140:143], v[148:151]
    v_mul_f32 v132, v97, v132
    v_mul_f32 v133, v97, v133
    ds_read_b128 v[176:179], v24 offset:0
    ds_read_b128 v[180:183], v25 offset:0
    s_waitcnt lgkmcnt(2)
    v_mfma_f32_16x16x32_bf16 v[128:131], a[148:151], v[168:171], v[128:131]
    v_mul_f32 v134, v97, v134
    v_mul_f32 v135, v97, v135
    v_mfma_f32_16x16x32_bf16 v[148:151], v[168:171], a[152:155], v[148:151]
    v_cvt_pk_bf16_f32 v76, v132, v133
    v_cvt_pk_bf16_f32 v77, v134, v135
    v_mfma_f32_16x16x32_bf16 v[128:131], a[160:163], v[172:175], v[128:131]
    v_fma_f32 v152, -v204, v34, v152
    v_fma_f32 v153, -v206, v34, v153
    v_mfma_f32_16x16x32_bf16 v[148:151], v[172:175], a[164:167], v[148:151]
    v_fma_f32 v154, -v208, v34, v154
    v_fma_f32 v155, -v210, v34, v155
    s_waitcnt lgkmcnt(0)
    v_mfma_f32_16x16x32_bf16 v[128:131], a[172:175], v[176:179], v[128:131]
    v_mul_f32 v152, v205, v152
    v_mul_f32 v153, v207, v153
    v_mfma_f32_16x16x32_bf16 v[148:151], v[176:179], a[176:179], v[148:151]
    v_mul_f32 v154, v209, v154
    v_mul_f32 v155, v211, v155
    v_mfma_f32_16x16x32_bf16 v[128:131], a[184:187], v[180:183], v[128:131]
    v_cvt_pk_bf16_f32 v86, v152, v153
    v_cvt_pk_bf16_f32 v87, v154, v155
    v_mfma_f32_16x16x32_bf16 v[148:151], v[180:183], a[188:191], v[148:151]
    ds_write_b64 v184, v[188:189]
    s_waitcnt lgkmcnt(0)
    ds_read_b64 v[94:95], v193 offset:0
    ds_read_b128 v[196:199], v194 offset:0
    ds_read_b128 v[200:203], v194 offset:16
    v_pk_fma_f32 v[116:117], v[26:27], v[98:99], v[116:117] op_sel_hi:[1,0,1] neg_lo:[0,1,0] neg_hi:[0,1,0]
    v_pk_fma_f32 v[118:119], v[28:29], v[98:99], v[118:119] op_sel_hi:[1,0,1] neg_lo:[0,1,0] neg_hi:[0,1,0]
    v_pk_mul_f32 v[116:117], v[116:117], v[98:99] op_sel:[0,1]
    v_pk_mul_f32 v[118:119], v[118:119], v[98:99] op_sel:[0,1]
    v_cvt_pk_bf16_f32 v68, v116, v117
    v_cvt_pk_bf16_f32 v69, v118, v119
    v_pk_fma_f32 v[136:137], v[30:31], v[98:99], v[136:137] op_sel_hi:[1,0,1] neg_lo:[0,1,0] neg_hi:[0,1,0]
    v_pk_fma_f32 v[138:139], v[32:33], v[98:99], v[138:139] op_sel_hi:[1,0,1] neg_lo:[0,1,0] neg_hi:[0,1,0]
    v_pk_mul_f32 v[136:137], v[136:137], v[98:99] op_sel:[0,1]
    v_pk_mul_f32 v[138:139], v[138:139], v[98:99] op_sel:[0,1]
    v_cvt_pk_bf16_f32 v78, v136, v137
    v_cvt_pk_bf16_f32 v79, v138, v139
    v_fma_f32 v156, -v212, v34, v156
    v_fma_f32 v157, -v214, v34, v157
    v_fma_f32 v158, -v216, v34, v158
    v_fma_f32 v159, -v218, v34, v159
    v_mul_f32 v156, v213, v156
    v_mul_f32 v157, v215, v157
    v_mul_f32 v158, v217, v158
    v_mul_f32 v159, v219, v159
    v_cvt_pk_bf16_f32 v88, v156, v157
    v_cvt_pk_bf16_f32 v89, v158, v159
    v_pk_fma_f32 v[120:121], v[26:27], v[100:101], v[120:121] op_sel_hi:[1,0,1] neg_lo:[0,1,0] neg_hi:[0,1,0]
    v_pk_fma_f32 v[122:123], v[28:29], v[100:101], v[122:123] op_sel_hi:[1,0,1] neg_lo:[0,1,0] neg_hi:[0,1,0]
    v_pk_mul_f32 v[120:121], v[120:121], v[100:101] op_sel:[0,1]
    v_pk_mul_f32 v[122:123], v[122:123], v[100:101] op_sel:[0,1]
    v_cvt_pk_bf16_f32 v70, v120, v121
    v_cvt_pk_bf16_f32 v71, v122, v123
    v_pk_fma_f32 v[140:141], v[30:31], v[100:101], v[140:141] op_sel_hi:[1,0,1] neg_lo:[0,1,0] neg_hi:[0,1,0]
    v_pk_fma_f32 v[142:143], v[32:33], v[100:101], v[142:143] op_sel_hi:[1,0,1] neg_lo:[0,1,0] neg_hi:[0,1,0]
    v_pk_mul_f32 v[140:141], v[140:141], v[100:101] op_sel:[0,1]
    v_pk_mul_f32 v[142:143], v[142:143], v[100:101] op_sel:[0,1]
    v_cvt_pk_bf16_f32 v80, v140, v141
    v_cvt_pk_bf16_f32 v81, v142, v143
    v_fma_f32 v160, -v220, v34, v160
    v_fma_f32 v161, -v222, v34, v161
    v_fma_f32 v162, -v224, v34, v162
    v_fma_f32 v163, -v226, v34, v163
    v_mul_f32 v160, v221, v160
    v_mul_f32 v161, v223, v161
    v_mul_f32 v162, v225, v162
    v_mul_f32 v163, v227, v163
    v_cvt_pk_bf16_f32 v90, v160, v161
    v_cvt_pk_bf16_f32 v91, v162, v163
    v_pk_fma_f32 v[124:125], v[26:27], v[102:103], v[124:125] op_sel_hi:[1,0,1] neg_lo:[0,1,0] neg_hi:[0,1,0]
    v_pk_fma_f32 v[126:127], v[28:29], v[102:103], v[126:127] op_sel_hi:[1,0,1] neg_lo:[0,1,0] neg_hi:[0,1,0]
    v_pk_mul_f32 v[124:125], v[124:125], v[102:103] op_sel:[0,1]
    v_pk_mul_f32 v[126:127], v[126:127], v[102:103] op_sel:[0,1]
    v_cvt_pk_bf16_f32 v72, v124, v125
    v_cvt_pk_bf16_f32 v73, v126, v127
    v_pk_fma_f32 v[144:145], v[30:31], v[102:103], v[144:145] op_sel_hi:[1,0,1] neg_lo:[0,1,0] neg_hi:[0,1,0]
    v_pk_fma_f32 v[146:147], v[32:33], v[102:103], v[146:147] op_sel_hi:[1,0,1] neg_lo:[0,1,0] neg_hi:[0,1,0]
    v_pk_mul_f32 v[144:145], v[144:145], v[102:103] op_sel:[0,1]
    v_pk_mul_f32 v[146:147], v[146:147], v[102:103] op_sel:[0,1]
    v_cvt_pk_bf16_f32 v82, v144, v145
    v_cvt_pk_bf16_f32 v83, v146, v147
    v_fma_f32 v164, -v228, v34, v164
    v_fma_f32 v165, -v230, v34, v165
    v_fma_f32 v166, -v232, v34, v166
    v_fma_f32 v167, -v234, v34, v167
    v_mul_f32 v164, v229, v164
    v_mul_f32 v165, v231, v165
    v_mul_f32 v166, v233, v166
    v_mul_f32 v167, v235, v167
    v_cvt_pk_bf16_f32 v92, v164, v165
    v_cvt_pk_bf16_f32 v93, v166, v167
    s_waitcnt lgkmcnt(0)
    v_pk_fma_f32 v[128:129], v[30:31], v[94:95], v[128:129] op_sel_hi:[1,0,1] neg_lo:[0,1,0] neg_hi:[0,1,0]
    v_pk_fma_f32 v[130:131], v[32:33], v[94:95], v[130:131] op_sel_hi:[1,0,1] neg_lo:[0,1,0] neg_hi:[0,1,0]
    v_pk_mul_f32 v[128:129], v[128:129], v[94:95] op_sel:[0,1]
    v_pk_mul_f32 v[130:131], v[130:131], v[94:95] op_sel:[0,1]
    v_cvt_pk_bf16_f32 v74, v128, v129
    v_cvt_pk_bf16_f32 v75, v130, v131
    v_fma_f32 v148, -v196, v34, v148
    v_fma_f32 v149, -v198, v34, v149
    v_fma_f32 v150, -v200, v34, v150
    v_fma_f32 v151, -v202, v34, v151
    v_mul_f32 v148, v197, v148
    v_mul_f32 v149, v199, v149
    v_mul_f32 v150, v201, v150
    v_mul_f32 v151, v203, v151
    v_cvt_pk_bf16_f32 v84, v148, v149
    v_cvt_pk_bf16_f32 v85, v150, v151
    s_nop 1
    v_mfma_f32_16x16x16_bf16 v[108:111], v[76:77], v[66:67], v[38:41]
    v_mfma_f32_16x16x16_bf16 v[124:127], v[74:75], v[66:67], v[46:49]
    v_mfma_f32_16x16x16_bf16 v[112:115], v[78:79], v[68:69], v[38:41]
    v_mfma_f32_16x16x16_bf16 v[128:131], v[76:77], v[68:69], v[42:45]
    v_mfma_f32_16x16x16_bf16 v[116:119], v[80:81], v[70:71], v[38:41]
    v_mfma_f32_16x16x16_bf16 v[132:135], v[78:79], v[70:71], v[42:45]
    v_mfma_f32_16x16x16_bf16 v[120:123], v[82:83], v[72:73], v[38:41]
    v_mfma_f32_16x16x16_bf16 v[136:139], v[80:81], v[72:73], v[42:45]
    s_nop 1
    v_max_f32 v108, v108, v124
    v_max_f32 v109, v109, v125
    v_max_f32 v110, v110, v126
    v_max_f32 v111, v111, v127
    v_max3_f32 v140, v108, v109, v110
    v_max_f32 v140, v140, v111
    v_max_f32 v112, v112, v128
    v_max_f32 v113, v113, v129
    v_max_f32 v114, v114, v130
    v_max_f32 v115, v115, v131
    v_max3_f32 v141, v112, v113, v114
    v_max_f32 v141, v141, v115
    v_max_f32 v116, v116, v132
    v_max_f32 v117, v117, v133
    v_max_f32 v118, v118, v134
    v_max_f32 v119, v119, v135
    v_max3_f32 v142, v116, v117, v118
    v_max_f32 v142, v142, v119
    s_nop 1
    v_max_f32 v120, v120, v136
    v_max_f32 v121, v121, v137
    v_max_f32 v122, v122, v138
    v_max_f32 v123, v123, v139
    v_max3_f32 v143, v120, v121, v122
    v_max_f32 v143, v143, v123
    v_mov_b32 v144, v140
    v_mov_b32 v145, v141
    v_mov_b32 v146, v142
    v_mov_b32 v147, v143
    s_nop 0
    v_permlane16_swap_b32 v140, v144
    v_permlane16_swap_b32 v141, v145
    v_permlane16_swap_b32 v142, v146
    v_permlane16_swap_b32 v143, v147
    s_nop 0
    v_max_f32 v140, v140, v144
    v_max_f32 v141, v141, v145
    v_max_f32 v142, v142, v146
    v_max_f32 v143, v143, v147
    v_mov_b32 v144, v140
    v_mov_b32 v145, v141
    v_mov_b32 v146, v142
    v_mov_b32 v147, v143
    s_nop 0
    v_permlane32_swap_b32 v140, v144
    v_permlane32_swap_b32 v141, v145
    v_permlane32_swap_b32 v142, v146
    v_permlane32_swap_b32 v143, v147
    s_nop 0
    v_max_f32 v140, v140, v144
    v_max_f32 v141, v141, v145
    v_max_f32 v142, v142, v146
    v_max_f32 v143, v143, v147
    v_mul_f32 v140, 0x3eb8aa3b, v140
    v_mul_f32 v141, 0x3eb8aa3b, v141
    v_mul_f32 v142, 0x3eb8aa3b, v142
    v_mul_f32 v143, 0x3eb8aa3b, v143
    v_fma_f32 v108, v108, s17, -v140
    v_fma_f32 v109, v109, s17, -v140
    v_fma_f32 v110, v110, s17, -v140
    v_fma_f32 v111, v111, s17, -v140
    v_fma_f32 v112, v112, s17, -v141
    v_fma_f32 v113, v113, s17, -v141
    v_fma_f32 v114, v114, s17, -v141
    v_fma_f32 v115, v115, s17, -v141
    v_fma_f32 v116, v116, s17, -v142
    v_fma_f32 v117, v117, s17, -v142
    v_fma_f32 v118, v118, s17, -v142
    v_fma_f32 v119, v119, s17, -v142
    v_fma_f32 v120, v120, s17, -v143
    v_fma_f32 v121, v121, s17, -v143
    v_fma_f32 v122, v122, s17, -v143
    v_fma_f32 v123, v123, s17, -v143
    v_exp_f32 v108, v108
    v_exp_f32 v109, v109
    v_exp_f32 v110, v110
    v_exp_f32 v111, v111
    v_exp_f32 v112, v112
    v_exp_f32 v113, v113
    v_exp_f32 v114, v114
    v_exp_f32 v115, v115
    v_exp_f32 v116, v116
    v_exp_f32 v117, v117
    v_exp_f32 v118, v118
    v_exp_f32 v119, v119
    v_exp_f32 v120, v120
    v_exp_f32 v121, v121
    v_exp_f32 v122, v122
    v_exp_f32 v123, v123
    s_nop 0
    v_cvt_pk_bf16_f32 v124, v108, v109
    v_cvt_pk_bf16_f32 v125, v110, v111
    v_and_b32 v148, v52, v124
    v_and_b32 v149, v53, v125
    v_and_b32 v150, v50, v124
    v_and_b32 v151, v51, v125
    v_cvt_pk_bf16_f32 v128, v112, v113
    v_cvt_pk_bf16_f32 v129, v114, v115
    v_and_b32 v152, v52, v128
    v_and_b32 v153, v53, v129
    v_and_b32 v154, v50, v128
    v_and_b32 v155, v51, v129
    v_cvt_pk_bf16_f32 v132, v116, v117
    v_cvt_pk_bf16_f32 v133, v118, v119
    v_and_b32 v156, v52, v132
    v_and_b32 v157, v53, v133
    v_and_b32 v158, v50, v132
    v_and_b32 v159, v51, v133
    v_cvt_pk_bf16_f32 v136, v120, v121
    v_cvt_pk_bf16_f32 v137, v122, v123
    v_and_b32 v160, v52, v136
    v_and_b32 v161, v53, v137
    v_and_b32 v162, v50, v136
    v_and_b32 v163, v51, v137
    s_nop 1
    v_mfma_f32_16x16x32_bf16 v[212:215], v[54:57], v[148:151], 0
    v_mfma_f32_16x16x32_bf16 v[196:199], v[84:87], v[148:151], 0
    v_mfma_f32_16x16x32_bf16 v[216:219], v[54:57], v[152:155], 0
    v_mfma_f32_16x16x32_bf16 v[200:203], v[86:89], v[152:155], 0
    v_mfma_f32_16x16x32_bf16 v[220:223], v[54:57], v[156:159], 0
    v_mfma_f32_16x16x32_bf16 v[204:207], v[88:91], v[156:159], 0
    v_mfma_f32_16x16x32_bf16 v[224:227], v[54:57], v[160:163], 0
    v_mfma_f32_16x16x32_bf16 v[208:211], v[90:93], v[160:163], 0
    s_nop 7
    v_rcp_f32 v212, v212
    v_rcp_f32 v216, v216
    v_rcp_f32 v220, v220
    v_rcp_f32 v224, v224
    s_nop 0
    v_pk_mul_f32 v[196:197], v[196:197], v[212:213] op_sel_hi:[1,0]
    v_pk_mul_f32 v[198:199], v[198:199], v[212:213] op_sel_hi:[1,0]
    v_cvt_pk_bf16_f32 v196, v196, v197
    v_cvt_pk_bf16_f32 v197, v198, v199
    v_pk_mul_f32 v[200:201], v[200:201], v[216:217] op_sel_hi:[1,0]
    v_pk_mul_f32 v[202:203], v[202:203], v[216:217] op_sel_hi:[1,0]
    v_cvt_pk_bf16_f32 v200, v200, v201
    v_cvt_pk_bf16_f32 v201, v202, v203
    v_pk_mul_f32 v[204:205], v[204:205], v[220:221] op_sel_hi:[1,0]
    v_pk_mul_f32 v[206:207], v[206:207], v[220:221] op_sel_hi:[1,0]
    v_cvt_pk_bf16_f32 v204, v204, v205
    v_cvt_pk_bf16_f32 v205, v206, v207
    v_pk_mul_f32 v[208:209], v[208:209], v[224:225] op_sel_hi:[1,0]
    v_pk_mul_f32 v[210:211], v[210:211], v[224:225] op_sel_hi:[1,0]
    v_cvt_pk_bf16_f32 v208, v208, v209
    v_cvt_pk_bf16_f32 v209, v210, v211
    s_cmp_eq_u32 s52, 0
    s_cbranch_scc1 L_sg_45
    s_add_u32 s75, s20, 0
    buffer_store_dwordx2 v[196:197], v254, s[12:15], s75 offen
    s_add_u32 s75, s20, 16384
    buffer_store_dwordx2 v[200:201], v254, s[12:15], s75 offen
    s_add_u32 s75, s20, 32768
    buffer_store_dwordx2 v[204:205], v254, s[12:15], s75 offen
    s_add_u32 s75, s20, 49152
    buffer_store_dwordx2 v[208:209], v254, s[12:15], s75 offen
    s_branch L_sj_46
L_sg_45:
    s_add_u32 s75, s20, 2097152
    buffer_store_dwordx2 v[196:197], v254, s[12:15], s75 offen sc1
    s_add_u32 s75, s20, 2113536
    buffer_store_dwordx2 v[200:201], v254, s[12:15], s75 offen sc1
    s_add_u32 s75, s20, 2129920
    buffer_store_dwordx2 v[204:205], v254, s[12:15], s75 offen sc1
    s_add_u32 s75, s20, 2146304
    buffer_store_dwordx2 v[208:209], v254, s[12:15], s75 offen sc1
L_sj_46:
    s_waitcnt vmcnt(0)
    s_add_u32 s74, s18, 11450368
    s_mov_b64 exec, 1
    s_cmp_eq_u32 s52, 0
    s_cbranch_scc1 L_sg_47
    buffer_store_dwordx2 v[36:37], v9, s[12:15], s74 offen
    s_branch L_sj_48
L_sg_47:
    buffer_store_dwordx2 v[36:37], v9, s[12:15], s74 offen sc1
L_sj_48:
    s_mov_b64 exec, -1
    s_lshl_b32 s82, s45, 8
    s_add_u32 s82, s82, 11450368
    buffer_load_dwordx2 v[232:233], v236, s[12:15], s82 offen sc1
    s_lshl_b32 s84, s45, 16
    s_lshl_b32 s85, s44, 14
    s_add_u32 s84, s84, s85
    s_cmp_eq_u32 s52, 0
    s_cselect_b32 s85, 2097152, 0
    s_add_u32 s84, s84, s85
    s_waitcnt vmcnt(0)
    s_mov_b32 s61, 0
L_po2_49:
    v_xor_b32 v68, s50, v232
    v_xor_b32 v69, s51, v233
    v_or_b32 v68, v68, v69
    v_cmp_ne_u32 vcc, 0, v68
    s_add_u32 s61, s61, 1
    s_cmp_gt_u32 s61, 40000
    s_cbranch_scc1 L_po2d_50
    s_nop 1
    s_cbranch_vccz L_po2d_50
    s_sleep 1
    buffer_load_dwordx2 v[232:233], v236, s[12:15], s82 offen sc1
    s_waitcnt vmcnt(0)
    s_branch L_po2_49
L_po2d_50:
    s_add_u32 s85, s84, 0
    buffer_load_dwordx4 a[192:195], v4, s[12:15], s85 offen offset:0 sc1
    buffer_load_dwordx4 a[196:199], v4, s[12:15], s85 offen offset:1024 sc1
    buffer_load_dwordx4 a[200:203], v4, s[12:15], s85 offen offset:2048 sc1
    buffer_load_dwordx4 a[204:207], v4, s[12:15], s85 offen offset:3072 sc1
    s_add_u32 s85, s84, 4096
    buffer_load_dwordx4 a[208:211], v4, s[12:15], s85 offen offset:0 sc1
    buffer_load_dwordx4 a[212:215], v4, s[12:15], s85 offen offset:1024 sc1
    s_lshl_b32 s75, s44, 15
    s_add_u32 s79, s56, s75
    ds_read_b64_tr_b16 v[112:113], v58 offset:0
    ds_read_b64_tr_b16 v[114:115], v58 offset:512
    ds_read_b64_tr_b16 v[116:117], v59 offset:0
    ds_read_b64_tr_b16 v[118:119], v59 offset:512
    ds_read_b64_tr_b16 v[120:121], v60 offset:0
    ds_read_b64_tr_b16 v[122:123], v60 offset:512
    ds_read_b64_tr_b16 v[124:125], v61 offset:0
    ds_read_b64_tr_b16 v[126:127], v61 offset:512
    ds_read_b64_tr_b16 v[144:145], v58 offset:4096
    ds_read_b64_tr_b16 v[146:147], v58 offset:4608
    ds_read_b64_tr_b16 v[148:149], v59 offset:4096
    ds_read_b64_tr_b16 v[150:151], v59 offset:4608
    ds_read_b64_tr_b16 v[152:153], v60 offset:4096
    ds_read_b64_tr_b16 v[154:155], v60 offset:4608
    ds_read_b64_tr_b16 v[156:157], v61 offset:4096
    ds_read_b64_tr_b16 v[158:159], v61 offset:4608
    s_waitcnt vmcnt(5) lgkmcnt(8)
    v_mfma_f32_16x16x32_bf16 v[80:83], v[112:115], a[192:195], 0
    buffer_load_dwordx4 a[216:219], v4, s[12:15], s85 offen offset:2048 sc1
    v_mfma_f32_16x16x32_bf16 v[84:87], v[116:119], a[192:195], 0
    ds_read_b64_tr_b16 v[176:177], v58 offset:8192
    ds_read_b64_tr_b16 v[178:179], v58 offset:8704
    ds_read_b64_tr_b16 v[180:181], v59 offset:8192
    ds_read_b64_tr_b16 v[182:183], v59 offset:8704
    v_mfma_f32_16x16x32_bf16 v[88:91], v[120:123], a[192:195], 0
    ds_read_b64_tr_b16 v[184:185], v60 offset:8192
    ds_read_b64_tr_b16 v[186:187], v60 offset:8704
    ds_read_b64_tr_b16 v[188:189], v61 offset:8192
    ds_read_b64_tr_b16 v[190:191], v61 offset:8704
    v_mfma_f32_16x16x32_bf16 v[92:95], v[124:127], a[192:195], 0
    s_waitcnt vmcnt(5) lgkmcnt(8)
    v_mfma_f32_16x16x32_bf16 v[80:83], v[144:147], a[196:199], v[80:83]
    buffer_load_dwordx4 a[220:223], v4, s[12:15], s85 offen offset:3072 sc1
    v_mfma_f32_16x16x32_bf16 v[84:87], v[148:151], a[196:199], v[84:87]
    ds_read_b64_tr_b16 v[112:113], v58 offset:12288
    ds_read_b64_tr_b16 v[114:115], v58 offset:12800
    ds_read_b64_tr_b16 v[116:117], v59 offset:12288
    ds_read_b64_tr_b16 v[118:119], v59 offset:12800
    v_mfma_f32_16x16x32_bf16 v[88:91], v[152:155], a[196:199], v[88:91]
    ds_read_b64_tr_b16 v[120:121], v60 offset:12288
    ds_read_b64_tr_b16 v[122:123], v60 offset:12800
    ds_read_b64_tr_b16 v[124:125], v61 offset:12288
    ds_read_b64_tr_b16 v[126:127], v61 offset:12800
    v_mfma_f32_16x16x32_bf16 v[92:95], v[156:159], a[196:199], v[92:95]
    s_waitcnt vmcnt(5) lgkmcnt(8)
    v_mfma_f32_16x16x32_bf16 v[80:83], v[176:179], a[200:203], v[80:83]
    s_add_u32 s85, s84, 8192
    buffer_load_dwordx4 a[224:227], v4, s[12:15], s85 offen offset:0 sc1
    v_mfma_f32_16x16x32_bf16 v[84:87], v[180:183], a[200:203], v[84:87]
    ds_read_b64_tr_b16 v[144:145], v58 offset:16384
    ds_read_b64_tr_b16 v[146:147], v58 offset:16896
    ds_read_b64_tr_b16 v[148:149], v59 offset:16384
    ds_read_b64_tr_b16 v[150:151], v59 offset:16896
    v_mfma_f32_16x16x32_bf16 v[88:91], v[184:187], a[200:203], v[88:91]
    ds_read_b64_tr_b16 v[152:153], v60 offset:16384
    ds_read_b64_tr_b16 v[154:155], v60 offset:16896
    ds_read_b64_tr_b16 v[156:157], v61 offset:16384
    ds_read_b64_tr_b16 v[158:159], v61 offset:16896
    v_mfma_f32_16x16x32_bf16 v[92:95], v[188:191], a[200:203], v[92:95]
    s_waitcnt vmcnt(5) lgkmcnt(8)
    v_mfma_f32_16x16x32_bf16 v[80:83], v[112:115], a[204:207], v[80:83]
    buffer_load_dwordx4 a[228:231], v4, s[12:15], s85 offen offset:1024 sc1
    v_mfma_f32_16x16x32_bf16 v[84:87], v[116:119], a[204:207], v[84:87]
    ds_read_b64_tr_b16 v[176:177], v58 offset:20480
    ds_read_b64_tr_b16 v[178:179], v58 offset:20992
    ds_read_b64_tr_b16 v[180:181], v59 offset:20480
    ds_read_b64_tr_b16 v[182:183], v59 offset:20992
    v_mfma_f32_16x16x32_bf16 v[88:91], v[120:123], a[204:207], v[88:91]
    ds_read_b64_tr_b16 v[184:185], v60 offset:20480
    ds_read_b64_tr_b16 v[186:187], v60 offset:20992
    ds_read_b64_tr_b16 v[188:189], v61 offset:20480
    ds_read_b64_tr_b16 v[190:191], v61 offset:20992
    v_mfma_f32_16x16x32_bf16 v[92:95], v[124:127], a[204:207], v[92:95]
    s_waitcnt vmcnt(5) lgkmcnt(8)
    v_mfma_f32_16x16x32_bf16 v[80:83], v[144:147], a[208:211], v[80:83]
    buffer_load_dwordx4 a[232:235], v4, s[12:15], s85 offen offset:2048 sc1
    v_mfma_f32_16x16x32_bf16 v[84:87], v[148:151], a[208:211], v[84:87]
    ds_read_b64_tr_b16 v[112:113], v58 offset:24576
    ds_read_b64_tr_b16 v[114:115], v58 offset:25088
    ds_read_b64_tr_b16 v[116:117], v59 offset:24576
    ds_read_b64_tr_b16 v[118:119], v59 offset:25088
    v_mfma_f32_16x16x32_bf16 v[88:91], v[152:155], a[208:211], v[88:91]
    ds_read_b64_tr_b16 v[120:121], v60 offset:24576
    ds_read_b64_tr_b16 v[122:123], v60 offset:25088
    ds_read_b64_tr_b16 v[124:125], v61 offset:24576
    ds_read_b64_tr_b16 v[126:127], v61 offset:25088
    v_mfma_f32_16x16x32_bf16 v[92:95], v[156:159], a[208:211], v[92:95]
    s_waitcnt vmcnt(5) lgkmcnt(8)
    v_mfma_f32_16x16x32_bf16 v[80:83], v[176:179], a[212:215], v[80:83]
    buffer_load_dwordx4 a[236:239], v4, s[12:15], s85 offen offset:3072 sc1
    v_mfma_f32_16x16x32_bf16 v[84:87], v[180:183], a[212:215], v[84:87]
    ds_read_b64_tr_b16 v[144:145], v58 offset:28672
    ds_read_b64_tr_b16 v[146:147], v58 offset:29184
    ds_read_b64_tr_b16 v[148:149], v59 offset:28672
    ds_read_b64_tr_b16 v[150:151], v59 offset:29184
    v_mfma_f32_16x16x32_bf16 v[88:91], v[184:187], a[212:215], v[88:91]
    ds_read_b64_tr_b16 v[152:153], v60 offset:28672
    ds_read_b64_tr_b16 v[154:155], v60 offset:29184
    ds_read_b64_tr_b16 v[156:157], v61 offset:28672
    ds_read_b64_tr_b16 v[158:159], v61 offset:29184
    v_mfma_f32_16x16x32_bf16 v[92:95], v[188:191], a[212:215], v[92:95]
    s_waitcnt vmcnt(5) lgkmcnt(8)
    v_mfma_f32_16x16x32_bf16 v[80:83], v[112:115], a[216:219], v[80:83]
    s_add_u32 s85, s84, 12288
    buffer_load_dwordx4 a[240:243], v4, s[12:15], s85 offen offset:0 sc1
    v_mfma_f32_16x16x32_bf16 v[84:87], v[116:119], a[216:219], v[84:87]
    ds_read_b64_tr_b16 v[176:177], v58 offset:32768
    ds_read_b64_tr_b16 v[178:179], v58 offset:33280
    ds_read_b64_tr_b16 v[180:181], v59 offset:32768
    ds_read_b64_tr_b16 v[182:183], v59 offset:33280
    v_mfma_f32_16x16x32_bf16 v[88:91], v[120:123], a[216:219], v[88:91]
    ds_read_b64_tr_b16 v[184:185], v60 offset:32768
    ds_read_b64_tr_b16 v[186:187], v60 offset:33280
    ds_read_b64_tr_b16 v[188:189], v61 offset:32768
    ds_read_b64_tr_b16 v[190:191], v61 offset:33280
    v_mfma_f32_16x16x32_bf16 v[92:95], v[124:127], a[216:219], v[92:95]
    s_waitcnt vmcnt(5) lgkmcnt(8)
    v_mfma_f32_16x16x32_bf16 v[80:83], v[144:147], a[220:223], v[80:83]
    buffer_load_dwordx4 a[244:247], v4, s[12:15], s85 offen offset:1024 sc1
    v_mfma_f32_16x16x32_bf16 v[84:87], v[148:151], a[220:223], v[84:87]
    ds_read_b64_tr_b16 v[112:113], v58 offset:36864
    ds_read_b64_tr_b16 v[114:115], v58 offset:37376
    ds_read_b64_tr_b16 v[116:117], v59 offset:36864
    ds_read_b64_tr_b16 v[118:119], v59 offset:37376
    v_mfma_f32_16x16x32_bf16 v[88:91], v[152:155], a[220:223], v[88:91]
    ds_read_b64_tr_b16 v[120:121], v60 offset:36864
    ds_read_b64_tr_b16 v[122:123], v60 offset:37376
    ds_read_b64_tr_b16 v[124:125], v61 offset:36864
    ds_read_b64_tr_b16 v[126:127], v61 offset:37376
    v_mfma_f32_16x16x32_bf16 v[92:95], v[156:159], a[220:223], v[92:95]
    s_waitcnt vmcnt(5) lgkmcnt(8)
    v_mfma_f32_16x16x32_bf16 v[80:83], v[176:179], a[224:227], v[80:83]
    buffer_load_dwordx4 a[248:251], v4, s[12:15], s85 offen offset:2048 sc1
    v_mfma_f32_16x16x32_bf16 v[84:87], v[180:183], a[224:227], v[84:87]
    ds_read_b64_tr_b16 v[144:145], v58 offset:40960
    ds_read_b64_tr_b16 v[146:147], v58 offset:41472
    ds_read_b64_tr_b16 v[148:149], v59 offset:40960
    ds_read_b64_tr_b16 v[150:151], v59 offset:41472
    v_mfma_f32_16x16x32_bf16 v[88:91], v[184:187], a[224:227], v[88:91]
    ds_read_b64_tr_b16 v[152:153], v60 offset:40960
    ds_read_b64_tr_b16 v[154:155], v60 offset:41472
    ds_read_b64_tr_b16 v[156:157], v61 offset:40960
    ds_read_b64_tr_b16 v[158:159], v61 offset:41472
    v_mfma_f32_16x16x32_bf16 v[92:95], v[188:191], a[224:227], v[92:95]
    s_waitcnt vmcnt(5) lgkmcnt(8)
    v_mfma_f32_16x16x32_bf16 v[80:83], v[112:115], a[228:231], v[80:83]
    buffer_load_dwordx4 a[252:255], v4, s[12:15], s85 offen offset:3072 sc1
    v_mfma_f32_16x16x32_bf16 v[84:87], v[116:119], a[228:231], v[84:87]
    ds_read_b64_tr_b16 v[176:177], v58 offset:45056
    ds_read_b64_tr_b16 v[178:179], v58 offset:45568
    ds_read_b64_tr_b16 v[180:181], v59 offset:45056
    ds_read_b64_tr_b16 v[182:183], v59 offset:45568
    v_mfma_f32_16x16x32_bf16 v[88:91], v[120:123], a[228:231], v[88:91]
    ds_read_b64_tr_b16 v[184:185], v60 offset:45056
    ds_read_b64_tr_b16 v[186:187], v60 offset:45568
    ds_read_b64_tr_b16 v[188:189], v61 offset:45056
    ds_read_b64_tr_b16 v[190:191], v61 offset:45568
    v_mfma_f32_16x16x32_bf16 v[92:95], v[124:127], a[228:231], v[92:95]
    s_waitcnt vmcnt(5) lgkmcnt(8)
    v_mfma_f32_16x16x32_bf16 v[80:83], v[144:147], a[232:235], v[80:83]
    ds_read_b64_tr_b16 v[112:113], v58 offset:49152
    ds_read_b64_tr_b16 v[114:115], v58 offset:49664
    ds_read_b64_tr_b16 v[116:117], v59 offset:49152
    ds_read_b64_tr_b16 v[118:119], v59 offset:49664
    v_mfma_f32_16x16x32_bf16 v[84:87], v[148:151], a[232:235], v[84:87]
    ds_read_b64_tr_b16 v[120:121], v60 offset:49152
    ds_read_b64_tr_b16 v[122:123], v60 offset:49664
    ds_read_b64_tr_b16 v[124:125], v61 offset:49152
    ds_read_b64_tr_b16 v[126:127], v61 offset:49664
    v_mfma_f32_16x16x32_bf16 v[88:91], v[152:155], a[232:235], v[88:91]
    v_mfma_f32_16x16x32_bf16 v[92:95], v[156:159], a[232:235], v[92:95]
    s_waitcnt vmcnt(4) lgkmcnt(8)
    v_mfma_f32_16x16x32_bf16 v[80:83], v[176:179], a[236:239], v[80:83]
    ds_read_b64_tr_b16 v[144:145], v58 offset:53248
    ds_read_b64_tr_b16 v[146:147], v58 offset:53760
    ds_read_b64_tr_b16 v[148:149], v59 offset:53248
    ds_read_b64_tr_b16 v[150:151], v59 offset:53760
    v_mfma_f32_16x16x32_bf16 v[84:87], v[180:183], a[236:239], v[84:87]
    ds_read_b64_tr_b16 v[152:153], v60 offset:53248
    ds_read_b64_tr_b16 v[154:155], v60 offset:53760
    ds_read_b64_tr_b16 v[156:157], v61 offset:53248
    ds_read_b64_tr_b16 v[158:159], v61 offset:53760
    v_mfma_f32_16x16x32_bf16 v[88:91], v[184:187], a[236:239], v[88:91]
    v_mfma_f32_16x16x32_bf16 v[92:95], v[188:191], a[236:239], v[92:95]
    s_waitcnt vmcnt(3) lgkmcnt(8)
    v_mfma_f32_16x16x32_bf16 v[80:83], v[112:115], a[240:243], v[80:83]
    ds_read_b64_tr_b16 v[176:177], v58 offset:57344
    ds_read_b64_tr_b16 v[178:179], v58 offset:57856
    ds_read_b64_tr_b16 v[180:181], v59 offset:57344
    ds_read_b64_tr_b16 v[182:183], v59 offset:57856
    v_mfma_f32_16x16x32_bf16 v[84:87], v[116:119], a[240:243], v[84:87]
    ds_read_b64_tr_b16 v[184:185], v60 offset:57344
    ds_read_b64_tr_b16 v[186:187], v60 offset:57856
    ds_read_b64_tr_b16 v[188:189], v61 offset:57344
    ds_read_b64_tr_b16 v[190:191], v61 offset:57856
    v_mfma_f32_16x16x32_bf16 v[88:91], v[120:123], a[240:243], v[88:91]
    v_mfma_f32_16x16x32_bf16 v[92:95], v[124:127], a[240:243], v[92:95]
    s_waitcnt vmcnt(2) lgkmcnt(8)
    v_mfma_f32_16x16x32_bf16 v[80:83], v[144:147], a[244:247], v[80:83]
    ds_read_b64_tr_b16 v[112:113], v58 offset:61440
    ds_read_b64_tr_b16 v[114:115], v58 offset:61952
    ds_read_b64_tr_b16 v[116:117], v59 offset:61440
    ds_read_b64_tr_b16 v[118:119], v59 offset:61952
    v_mfma_f32_16x16x32_bf16 v[84:87], v[148:151], a[244:247], v[84:87]
    ds_read_b64_tr_b16 v[120:121], v60 offset:61440
    ds_read_b64_tr_b16 v[122:123], v60 offset:61952
    ds_read_b64_tr_b16 v[124:125], v61 offset:61440
    ds_read_b64_tr_b16 v[126:127], v61 offset:61952
    v_mfma_f32_16x16x32_bf16 v[88:91], v[152:155], a[244:247], v[88:91]
    v_mfma_f32_16x16x32_bf16 v[92:95], v[156:159], a[244:247], v[92:95]
    s_waitcnt vmcnt(1) lgkmcnt(8)
    v_mfma_f32_16x16x32_bf16 v[80:83], v[176:179], a[248:251], v[80:83]
    v_mfma_f32_16x16x32_bf16 v[84:87], v[180:183], a[248:251], v[84:87]
    v_mfma_f32_16x16x32_bf16 v[88:91], v[184:187], a[248:251], v[88:91]
    v_mfma_f32_16x16x32_bf16 v[92:95], v[188:191], a[248:251], v[92:95]
    s_waitcnt vmcnt(0) lgkmcnt(0)
    v_mfma_f32_16x16x32_bf16 v[80:83], v[112:115], a[252:255], v[80:83]
    v_mfma_f32_16x16x32_bf16 v[84:87], v[116:119], a[252:255], v[84:87]
    v_mfma_f32_16x16x32_bf16 v[88:91], v[120:123], a[252:255], v[88:91]
    v_mfma_f32_16x16x32_bf16 v[92:95], v[124:127], a[252:255], v[92:95]
    v_lshlrev_b32 v144, 16, v238
    v_and_b32 v145, 0xffff0000, v238
    v_lshlrev_b32 v146, 16, v239
    v_and_b32 v147, 0xffff0000, v239
    v_lshlrev_b32 v148, 16, v240
    v_and_b32 v149, 0xffff0000, v240
    v_lshlrev_b32 v150, 16, v241
    v_and_b32 v151, 0xffff0000, v241
    v_lshlrev_b32 v152, 16, v242
    v_and_b32 v153, 0xffff0000, v242
    v_lshlrev_b32 v154, 16, v243
    v_and_b32 v155, 0xffff0000, v243
    v_lshlrev_b32 v156, 16, v244
    v_and_b32 v157, 0xffff0000, v244
    v_lshlrev_b32 v158, 16, v245
    v_and_b32 v159, 0xffff0000, v245
    v_mov_b32 v168, 0
    v_mov_b32 v169, 0
    v_mov_b32 v170, s50
    v_mov_b32 v171, s51
    v_pk_add_f32 v[144:145], v[144:145], v[80:81]
    v_cvt_pk_bf16_f32 v160, v144, v145
    v_pk_add_f32 v[146:147], v[146:147], v[82:83]
    v_cvt_pk_bf16_f32 v161, v146, v147
    v_pk_add_f32 v[148:149], v[148:149], v[84:85]
    v_cvt_pk_bf16_f32 v162, v148, v149
    v_pk_add_f32 v[150:151], v[150:151], v[86:87]
    v_cvt_pk_bf16_f32 v163, v150, v151
    v_pk_add_f32 v[152:153], v[152:153], v[88:89]
    v_cvt_pk_bf16_f32 v164, v152, v153
    v_pk_add_f32 v[154:155], v[154:155], v[90:91]
    v_cvt_pk_bf16_f32 v165, v154, v155
    v_pk_add_f32 v[156:157], v[156:157], v[92:93]
    v_cvt_pk_bf16_f32 v166, v156, v157
    v_pk_add_f32 v[158:159], v[158:159], v[94:95]
    v_cvt_pk_bf16_f32 v167, v158, v159
    v_dot2_f32_bf16 v168, v160, v54, v168
    v_dot2_f32_bf16 v169, v160, v160, v169
    v_dot2_f32_bf16 v168, v161, v54, v168
    v_dot2_f32_bf16 v169, v161, v161, v169
    v_dot2_f32_bf16 v168, v162, v54, v168
    v_dot2_f32_bf16 v169, v162, v162, v169
    v_dot2_f32_bf16 v168, v163, v54, v168
    v_dot2_f32_bf16 v169, v163, v163, v169
    v_dot2_f32_bf16 v168, v164, v54, v168
    v_dot2_f32_bf16 v169, v164, v164, v169
    v_dot2_f32_bf16 v168, v165, v54, v168
    v_dot2_f32_bf16 v169, v165, v165, v169
    v_dot2_f32_bf16 v168, v166, v54, v168
    v_dot2_f32_bf16 v169, v166, v166, v169
    v_dot2_f32_bf16 v168, v167, v54, v168
    v_dot2_f32_bf16 v169, v167, v167, v169
    s_lshl_b32 s80, s45, 13
    s_lshl_b32 s75, s44, 11
    s_add_u32 s80, s80, s75
    s_add_u32 s80, s80, 10747904
    s_lshl_b32 s75, s46, 8
    s_add_u32 s75, s75, s80
    v_mov_b32 v172, v168
    v_mov_b32 v173, v169
    s_nop 0
    v_permlane16_swap_b32 v168, v172
    v_permlane16_swap_b32 v169, v173
    s_nop 0
    v_add_f32 v168, v168, v172
    v_add_f32 v169, v169, v173
    v_mov_b32 v172, v168
    v_mov_b32 v173, v169
    s_nop 0
    v_permlane32_swap_b32 v168, v172
    v_permlane32_swap_b32 v169, v173
    s_nop 0
    v_add_f32 v168, v168, v172
    v_add_f32 v169, v169, v173
    s_mov_b64 exec, 0xffff
    s_cmp_eq_u32 s52, 0
    s_cbranch_scc1 L_sg_51
    buffer_store_dwordx4 v[168:171], v4, s[12:15], s75 offen
    s_branch L_sj_52
L_sg_51:
    buffer_store_dwordx4 v[168:171], v4, s[12:15], s75 offen sc1
L_sj_52:
    s_mov_b64 exec, -1
    v_lshlrev_b32 v144, 16, v160
    v_and_b32 v145, 0xffff0000, v160
    v_lshlrev_b32 v146, 16, v161
    v_and_b32 v147, 0xffff0000, v161
    v_lshlrev_b32 v148, 16, v162
    v_and_b32 v149, 0xffff0000, v162
    v_lshlrev_b32 v150, 16, v163
    v_and_b32 v151, 0xffff0000, v163
    v_lshlrev_b32 v152, 16, v164
    v_and_b32 v153, 0xffff0000, v164
    v_lshlrev_b32 v154, 16, v165
    v_and_b32 v155, 0xffff0000, v165
    v_lshlrev_b32 v156, 16, v166
    v_and_b32 v157, 0xffff0000, v166
    v_lshlrev_b32 v158, 16, v167
    v_and_b32 v159, 0xffff0000, v167
    buffer_load_dwordx4 v[176:179], v4, s[12:15], s80 offen sc1
    buffer_load_dwordx4 v[180:183], v4, s[12:15], s80 offen offset:1024 sc1
    s_waitcnt vmcnt(0)
    s_mov_b32 s61, 0
L_pst_53:
    v_xor_b32 v76, s50, v178
    v_xor_b32 v77, s51, v179
    v_or_b32 v76, v76, v77
    v_xor_b32 v77, s50, v182
    v_or_b32 v76, v76, v77
    v_xor_b32 v77, s51, v183
    v_or_b32 v76, v76, v77
    v_cmp_ne_u32 vcc, 0, v76
    s_add_u32 s61, s61, 1
    s_cmp_gt_u32 s61, 40000
    s_cbranch_scc1 L_pstd_54
    s_nop 1
    s_cbranch_vccz L_pstd_54
    s_sleep 1
    buffer_load_dwordx4 v[176:179], v4, s[12:15], s80 offen sc1
    buffer_load_dwordx4 v[180:183], v4, s[12:15], s80 offen offset:1024 sc1
    s_waitcnt vmcnt(0)
    s_branch L_pst_53
L_pstd_54:
    v_add_f32 v168, v176, v180
    v_add_f32 v169, v177, v181
    v_mov_b32 v172, v168
    v_mov_b32 v173, v169
    s_nop 0
    v_permlane16_swap_b32 v168, v172
    v_permlane16_swap_b32 v169, v173
    s_nop 0
    v_add_f32 v168, v168, v172
    v_add_f32 v169, v169, v173
    v_mov_b32 v172, v168
    v_mov_b32 v173, v169
    s_nop 0
    v_permlane32_swap_b32 v168, v172
    v_permlane32_swap_b32 v169, v173
    s_nop 0
    v_add_f32 v168, v168, v172
    v_add_f32 v169, v169, v173
    v_mul_f32 v168, 0x3b000000, v168
    v_mul_f32 v169, 0x3b000000, v169
    v_fma_f32 v169, -v168, v168, v169
    v_max_f32 v169, 0, v169
    v_cvt_pk_bf16_f32 v172, v168, v169
    v_lshlrev_b32 v168, 16, v172
    v_and_b32 v169, 0xffff0000, v172
    v_add_f32 v169, 0x3727c5ac, v169
    v_cvt_pk_bf16_f32 v169, v169, v169
    v_lshlrev_b32 v169, 16, v169
    v_sqrt_f32 v169, v169
    s_nop 0
    v_cvt_pk_bf16_f32 v169, v169, v169
    v_lshlrev_b32 v169, 16, v169
    v_rcp_f32 v169, v169
    s_nop 0
    s_waitcnt lgkmcnt(0)
    v_lshlrev_b32 v192, 16, v246
    v_and_b32 v193, 0xffff0000, v246
    v_lshlrev_b32 v194, 16, v247
    v_and_b32 v195, 0xffff0000, v247
    v_lshlrev_b32 v196, 16, v248
    v_and_b32 v197, 0xffff0000, v248
    v_lshlrev_b32 v198, 16, v249
    v_and_b32 v199, 0xffff0000, v249
    v_lshlrev_b32 v200, 16, v250
    v_and_b32 v201, 0xffff0000, v250
    v_lshlrev_b32 v202, 16, v251
    v_and_b32 v203, 0xffff0000, v251
    v_lshlrev_b32 v204, 16, v252
    v_and_b32 v205, 0xffff0000, v252
    v_lshlrev_b32 v206, 16, v253
    v_and_b32 v207, 0xffff0000, v253
    v_pk_add_f32 v[208:209], v[144:145], v[168:169] op_sel_hi:[1,0] neg_lo:[0,1] neg_hi:[0,1]
    v_pk_mul_f32 v[208:209], v[208:209], v[168:169] op_sel:[0,1]
    v_pk_fma_f32 v[208:209], v[208:209], v[192:193], v[144:145]
    v_cvt_pk_bf16_f32 v160, v208, v209
    v_pk_add_f32 v[210:211], v[146:147], v[168:169] op_sel_hi:[1,0] neg_lo:[0,1] neg_hi:[0,1]
    v_pk_mul_f32 v[210:211], v[210:211], v[168:169] op_sel:[0,1]
    v_pk_fma_f32 v[210:211], v[210:211], v[194:195], v[146:147]
    v_cvt_pk_bf16_f32 v161, v210, v211
    v_pk_add_f32 v[212:213], v[148:149], v[168:169] op_sel_hi:[1,0] neg_lo:[0,1] neg_hi:[0,1]
    v_pk_mul_f32 v[212:213], v[212:213], v[168:169] op_sel:[0,1]
    v_pk_fma_f32 v[212:213], v[212:213], v[196:197], v[148:149]
    v_cvt_pk_bf16_f32 v162, v212, v213
    v_pk_add_f32 v[214:215], v[150:151], v[168:169] op_sel_hi:[1,0] neg_lo:[0,1] neg_hi:[0,1]
    v_pk_mul_f32 v[214:215], v[214:215], v[168:169] op_sel:[0,1]
    v_pk_fma_f32 v[214:215], v[214:215], v[198:199], v[150:151]
    v_cvt_pk_bf16_f32 v163, v214, v215
    v_pk_add_f32 v[216:217], v[152:153], v[168:169] op_sel_hi:[1,0] neg_lo:[0,1] neg_hi:[0,1]
    v_pk_mul_f32 v[216:217], v[216:217], v[168:169] op_sel:[0,1]
    v_pk_fma_f32 v[216:217], v[216:217], v[200:201], v[152:153]
    v_cvt_pk_bf16_f32 v164, v216, v217
    v_pk_add_f32 v[218:219], v[154:155], v[168:169] op_sel_hi:[1,0] neg_lo:[0,1] neg_hi:[0,1]
    v_pk_mul_f32 v[218:219], v[218:219], v[168:169] op_sel:[0,1]
    v_pk_fma_f32 v[218:219], v[218:219], v[202:203], v[154:155]
    v_cvt_pk_bf16_f32 v165, v218, v219
    v_pk_add_f32 v[220:221], v[156:157], v[168:169] op_sel_hi:[1,0] neg_lo:[0,1] neg_hi:[0,1]
    v_pk_mul_f32 v[220:221], v[220:221], v[168:169] op_sel:[0,1]
    v_pk_fma_f32 v[220:221], v[220:221], v[204:205], v[156:157]
    v_cvt_pk_bf16_f32 v166, v220, v221
    v_pk_add_f32 v[222:223], v[158:159], v[168:169] op_sel_hi:[1,0] neg_lo:[0,1] neg_hi:[0,1]
    v_pk_mul_f32 v[222:223], v[222:223], v[168:169] op_sel:[0,1]
    v_pk_fma_f32 v[222:223], v[222:223], v[206:207], v[158:159]
    v_cvt_pk_bf16_f32 v167, v222, v223
    v_mov_b32 v208, v160
    v_mov_b32 v209, v161
    v_mov_b32 v210, v162
    v_mov_b32 v211, v163
    v_mov_b32 v212, v164
    v_mov_b32 v213, v165
    v_mov_b32 v214, v166
    v_mov_b32 v215, v167
    s_nop 1
    v_permlane16_swap_b32 v208, v210
    v_permlane16_swap_b32 v209, v211
    v_permlane16_swap_b32 v212, v214
    v_permlane16_swap_b32 v213, v215
    s_nop 0
    buffer_store_dwordx4 v[208:211], v237, s[36:39], s79 offen offset:0
    buffer_store_dwordx4 v[212:215], v237, s[36:39], s79 offen offset:64
    s_nop 0
L_end_1:
    s_endpgm
    .set CODE_LIMIT, L_end_1 - interleave_layers__sliding_local_dilated__ssm_conv_h3__prompt_kernel
.section .rodata,"a"
.p2align 6
.amdhsa_kernel interleave_layers__sliding_local_dilated__ssm_conv_h3__prompt_kernel
  .amdhsa_next_free_vgpr 512
  .amdhsa_next_free_sgpr 102
  .amdhsa_accum_offset 256
  .amdhsa_group_segment_fixed_size 0
  .amdhsa_kernarg_size 96
  .amdhsa_user_sgpr_count 2
  .amdhsa_user_sgpr_kernarg_segment_ptr 1
  .amdhsa_system_sgpr_workgroup_id_x 1
.end_amdhsa_kernel
```
